```python
import torch

def _softmax(x, axis=-1):
    return torch.softmax(x, dim=axis)
def _gelu(x):
    return torch.nn.functional.gelu(x, approximate="tanh")
def _silu(x):
    return torch.nn.functional.silu(x)
def _sigmoid(x):
    return torch.sigmoid(x)
def _layernorm(x, axis=-1, eps=1e-5):
    m = x.mean(dim=axis, keepdim=True)
    v = x.var(dim=axis, keepdim=True, unbiased=False)
    return (x - m) / torch.sqrt(v + eps)
def _scatter_add(tgt, idx, src, axis=0):
    return tgt.clone().index_add_(axis, idx, src)
def _segment_sum(src, seg, n):
    out = torch.zeros((n,) + src.shape[1:], dtype=src.dtype)
    return out.index_add_(0, seg, src)
def _pad(x, pw):
    flat = tuple(v for pair in reversed(pw) for v in pair)
    return torch.nn.functional.pad(x, flat)

kernel_name = 'parallel_sum__ssm_conv_s4d__moe_arch_mod__prompt'

def setup_inputs():

    _w = (lambda a: (lambda t: t.to(torch.bfloat16) if t.is_floating_point() else t)(torch.as_tensor(a)))
    def _A_setup():
        Bsz, L, D, N = 1, 2048, 512, 128
        return {
            "u": _w((lambda *s: torch.randn(*s, dtype=torch.bfloat16) * 0.05)(Bsz, L, D)),
            "log_A_real": _w((lambda *s: torch.randn(*s, dtype=torch.bfloat16) * 3.2)(D, N) * 0.5),
            "A_imag": _w((lambda *s: torch.randn(*s, dtype=torch.bfloat16) * 0.1)(D, N) * 3.14),
            "C_real": _w((lambda *s: torch.randn(*s, dtype=torch.bfloat16) * 0.8)(D, N) / N ** 0.5),
            "C_imag": _w((lambda *s: torch.randn(*s, dtype=torch.bfloat16) * 0.8)(D, N) / N ** 0.5),
            "log_dt": _w((lambda *s: torch.randn(*s, dtype=torch.bfloat16) * 0.1)(D) * 0.5 - 4.0),
            "D_skip": _w((lambda *s: torch.randn(*s, dtype=torch.bfloat16) * 0.1)(D)),
        }
    _A_in = _A_setup()

    def _B_setup():
        B, S, D, F, C = 1, 2048, 512, 1792, 2
        return {
            "x": _w((lambda *s: torch.randn(*s, dtype=torch.bfloat16) * 0.05)(B, S, D)),
            "w_r": _w((lambda *s: torch.randn(*s, dtype=torch.bfloat16) * 0.05)(D)),
            "w_gate": _w((lambda *s: torch.randn(*s, dtype=torch.bfloat16) * 0.05)(D, F)),
            "w_up": _w((lambda *s: torch.randn(*s, dtype=torch.bfloat16) * 0.05)(D, F)),
            "w_down": _w((lambda *s: torch.randn(*s, dtype=torch.bfloat16) * 0.05)(F, D)),
        }
    _B_in = _B_setup()

    return {
        "A_u": _A_in["u"],
        "A_log_A_real": _A_in["log_A_real"],
        "A_A_imag": _A_in["A_imag"],
        "A_C_real": _A_in["C_real"],
        "A_C_imag": _A_in["C_imag"],
        "A_log_dt": _A_in["log_dt"],
        "A_D_skip": _A_in["D_skip"],
        "B_x": _B_in["x"],
        "B_w_r": _B_in["w_r"],
        "B_w_gate": _B_in["w_gate"],
        "B_w_up": _B_in["w_up"],
        "B_w_down": _B_in["w_down"],
    }

def reference(A_u, A_log_A_real, A_A_imag, A_C_real, A_C_imag, A_log_dt, A_D_skip, B_x, B_w_r, B_w_gate, B_w_up, B_w_down):
    def _A_ref(u, log_A_real, A_imag, C_real, C_imag, log_dt, D_skip):
        L = u.shape[1]
        dt = torch.exp(log_dt)
        A = -torch.exp(log_A_real) + 1j * A_imag
        C = (C_real + 1j * C_imag) * dt[:, None]
        pos = (lambda x, dt: x.to(dt))(torch.arange(L), log_dt.dtype)
        P = torch.exp((A * dt[:, None])[:, :, None] * pos[None, None, :])
        K = 2.0 * torch.einsum("dn,dnl->dl", C, P).real
        L2 = 2 * L
        u_t = (lambda x, *d: x.permute(*d))(u, 0, 2, 1)
        Kf = (lambda x, *a, **k: torch.fft.rfft(x.float(), *a, **k))(K, L2)
        Uf = (lambda x, *a, **k: torch.fft.rfft(x.float(), *a, **k))(u_t, L2)
        y = (lambda x, *a, **k: torch.fft.irfft(x, *a, **k).to(torch.bfloat16))(Uf * Kf[None, :, :], L2)[:, :, :L]
        y = (lambda x, *d: x.permute(*d))(y, 0, 2, 1)
        return y + u * D_skip[None, None, :]

    def _B_ref(x, w_r, w_gate, w_up, w_down):
        B, S, D = x.shape
        C = 2
        r = x @ w_r
        idx = torch.argsort(-r, axis=-1)[:, :C]
        idx_e = (lambda x, n, axis: torch.repeat_interleave(x, n, dim=axis))(idx.reshape(B, C, 1), D, axis=2)
        x_sel = (lambda x, i, axis: torch.take_along_dim(x, i, dim=axis))(x, idx_e, axis=1)
        g = _silu(x_sel @ w_gate)
        u = x_sel @ w_up
        y = (g * u) @ w_down
        r_sel = _sigmoid((lambda x, i, axis: torch.take_along_dim(x, i, dim=axis))(r, idx, axis=1))
        y = y * r_sel.reshape(B, C, 1)
        b_off = (torch.arange(B) * S).reshape(B, 1)
        flat_idx = (idx + b_off).reshape(B * C)
        zero = (x * 0.0).reshape(B * S, D)
        upd = _scatter_add(zero, flat_idx, y.reshape(B * C, D), axis=0)
        return x + upd.reshape(B, S, D)

    x = A_u
    xn = _layernorm(x, axis=-1)
    return x + _A_ref(xn, A_log_A_real, A_A_imag, A_C_real, A_C_imag, A_log_dt, A_D_skip) + _B_ref(xn, B_w_r, B_w_gate, B_w_up, B_w_down)
```

```asm
; @launch grid=(256,1,1) block=(640,1,1) lds=143824
.amdgcn_target "amdgcn-amd-amdhsa--gfx950"
.text
.globl parallel_sum__ssm_conv_s4d__moe_arch_mod__prompt_kernel
.p2align 8
.type parallel_sum__ssm_conv_s4d__moe_arch_mod__prompt_kernel,@function
parallel_sum__ssm_conv_s4d__moe_arch_mod__prompt_kernel:
    s_cmp_ge_u32 s2, 256
    s_cbranch_scc1 L_end
    s_load_dwordx16 s[4:19], s[0:1], 0
    s_load_dwordx8 s[20:27], s[0:1], 64
    s_load_dwordx2 s[28:29], s[0:1], 96
    s_load_dwordx2 s[30:31], s[0:1], 112
    v_lshrrev_b32 v16, 6, v0
    v_and_b32 v1, 63, v0
    v_readfirstlane_b32 s32, v16
    s_and_b32 s3, s2, 7
    s_lshl_b32 s3, s3, 5
    s_lshr_b32 s38, s2, 3
    s_add_u32 s3, s3, s38
    s_cmp_lt_u32 s32, 4
    s_cbranch_scc1 L_c0
    s_cmp_ge_u32 s32, 8
    s_cbranch_scc1 L_notmain
    s_sub_u32 s35, s32, 4
    s_lshr_b32 s36, s35, 1
    s_and_b32 s37, s35, 1
    s_lshl_b32 s42, s3, 1
    s_add_u32 s42, s42, s36
    s_lshl_b32 s42, s42, 8
    s_lshl_b32 s39, s37, 7
    s_add_u32 s42, s42, s39
    v_lshl_add_u32 v18, v1, 1, s42
    v_subrev_u32 v2, 256, v0
    v_and_b32 v19, 0xfe, v2
    s_lshl_b32 s39, s3, 2
    s_waitcnt lgkmcnt(0)
    global_load_ushort v28, v18, s[6:7] nt
    global_load_ushort v29, v18, s[8:9] nt
    global_load_ushort v30, v18, s[10:11] nt
    global_load_ushort v31, v18, s[12:13] nt
    s_load_dword s40, s[14:15], s39
    s_load_dword s33, s[30:31], 0
    global_load_ushort v12, v19, s[16:17] offset:0
    global_load_ushort v13, v19, s[16:17] offset:256
    global_load_ushort v14, v19, s[16:17] offset:512
    global_load_ushort v15, v19, s[16:17] offset:768
    s_branch L_tmain
L_notmain:
    s_cmp_eq_u32 s32, 8
    s_cbranch_scc1 L_aux
    s_branch L_aux2
L_c0:
    v_lshrrev_b32 v16, 5, v1
    s_lshl_b32 s34, s2, 3
    s_lshl_b32 s35, s32, 1
    s_add_u32 s34, s34, s35
    v_add_u32 v17, s34, v16
    v_and_b32 v18, 31, v1
    v_lshlrev_b32 v18, 4, v18
    v_lshlrev_b32 v19, 10, v17
    v_add_u32 v20, v19, v18
    s_waitcnt lgkmcnt(0)
    global_load_dwordx4 v[100:103], v20, s[4:5] nt
    global_load_dwordx4 v[104:107], v20, s[4:5] offset:512 nt
    global_load_ushort v108, v19, s[4:5]
    s_load_dword s33, s[30:31], 0
    global_load_dwordx4 v[24:27], v18, s[20:21]
    global_load_dwordx4 v[28:31], v18, s[20:21] offset:512
    s_getpc_b64 s[42:43]
L_pc:
    s_sub_u32 s42, s42, L_pc-parallel_sum__ssm_conv_s4d__moe_arch_mod__prompt_kernel
    s_subb_u32 s43, s43, 0
    s_lshl_b32 s39, s32, 13
    v_lshl_add_u32 v53, v1, 7, s39
    s_cmp_lt_u32 s2, 8
    s_cselect_b32 s39, L_codeend-parallel_sum__ssm_conv_s4d__moe_arch_mod__prompt_kernel-4, 0
    v_min_u32 v53, s39, v53
    v_mov_b32 v55, s43
    v_add_co_u32 v54, vcc, s42, v53
    s_nop 1
    v_addc_co_u32 v55, vcc, 0, v55, vcc
    global_load_dword v150, v[54:55], off
    s_mov_b32 s60, 0x3fb8aa00
    s_mov_b32 s61, 0x36eca570
    s_mov_b32 s62, 0xffff0000
    s_mov_b32 s63, 0x80000000
    s_setprio 2
    v_add_u32 v16, s35, v16
    v_mul_u32_u24 v2, 1040, v16
    s_mov_b32 s38, 69632
    v_add3_u32 v2, v2, v18, s38
    v_lshl_add_u32 v21, v16, 2, 0
    v_add_u32 v21, 86272, v21
    v_sub_u32 v20, 0xffff, v17
    v_lshl_add_u32 v22, v16, 2, 0
    v_add_u32 v22, 86304, v22
    v_mov_b32 v23, 0x3f803f80
    v_and_b32 v16, 1, v0
    v_mul_u32_u24 v3, 4160, v16
    v_and_b32 v16, 0xfe, v0
    v_add3_u32 v3, v3, v16, s38
    v_and_b32 v16, 3, v0
    v_cmp_eq_u32 s[64:65], 0, v16
    v_cmp_eq_u32 s[66:67], 1, v16
    v_mov_b32 v4, 86272
    v_lshrrev_b32 v5, 2, v0
    v_mul_u32_u24 v5, 16384, v5
    v_lshl_add_u32 v5, v16, 4, v5
    s_lshl_b32 s39, s2, 6
    s_add_u32 s39, s39, 0x100000
    s_add_u32 s44, s30, s39
    s_addc_u32 s45, s31, 0
    s_add_u32 s46, s44, 1048576
    s_addc_u32 s47, s45, 0
    s_add_u32 s48, s46, 1048576
    s_addc_u32 s49, s47, 0
    s_add_u32 s50, s48, 1048576
    s_addc_u32 s51, s49, 0
    s_lshr_b32 s36, s32, 1
    s_and_b32 s37, s32, 1
    s_waitcnt vmcnt(3) lgkmcnt(0)
    s_add_u32 s33, s33, 0x9e3779b9
    v_lshlrev_b32 v52, 16, v108
    v_lshlrev_b32 v64, 16, v100
    v_and_b32 v65, s62, v100
    v_lshlrev_b32 v66, 16, v101
    v_and_b32 v67, s62, v101
    v_lshlrev_b32 v68, 16, v102
    v_and_b32 v69, s62, v102
    v_lshlrev_b32 v70, 16, v103
    v_and_b32 v71, s62, v103
    v_lshlrev_b32 v72, 16, v104
    v_and_b32 v73, s62, v104
    v_lshlrev_b32 v74, 16, v105
    v_and_b32 v75, s62, v105
    v_lshlrev_b32 v76, 16, v106
    v_and_b32 v77, s62, v106
    v_lshlrev_b32 v78, 16, v107
    v_and_b32 v79, s62, v107
    ds_write_b128 v2, v[100:103]
    ds_write_b128 v2, v[104:107] offset:512
    v_pk_add_f32 v[80:81], v[64:65], v[52:53] op_sel_hi:[1,0] neg_lo:[0,1] neg_hi:[0,1]
    v_pk_add_f32 v[82:83], v[66:67], v[52:53] op_sel_hi:[1,0] neg_lo:[0,1] neg_hi:[0,1]
    v_pk_add_f32 v[84:85], v[68:69], v[52:53] op_sel_hi:[1,0] neg_lo:[0,1] neg_hi:[0,1]
    v_pk_add_f32 v[86:87], v[70:71], v[52:53] op_sel_hi:[1,0] neg_lo:[0,1] neg_hi:[0,1]
    v_pk_add_f32 v[88:89], v[72:73], v[52:53] op_sel_hi:[1,0] neg_lo:[0,1] neg_hi:[0,1]
    v_pk_add_f32 v[90:91], v[74:75], v[52:53] op_sel_hi:[1,0] neg_lo:[0,1] neg_hi:[0,1]
    v_pk_add_f32 v[92:93], v[76:77], v[52:53] op_sel_hi:[1,0] neg_lo:[0,1] neg_hi:[0,1]
    v_pk_add_f32 v[94:95], v[78:79], v[52:53] op_sel_hi:[1,0] neg_lo:[0,1] neg_hi:[0,1]
    v_mov_b32 v54, 0
    v_mov_b32 v55, 0
    v_dot2_f32_bf16 v54, v100, v23, v54
    v_dot2_f32_bf16 v55, v101, v23, v55
    v_dot2_f32_bf16 v54, v102, v23, v54
    v_dot2_f32_bf16 v55, v103, v23, v55
    v_dot2_f32_bf16 v54, v104, v23, v54
    v_dot2_f32_bf16 v55, v105, v23, v55
    v_dot2_f32_bf16 v54, v106, v23, v54
    v_dot2_f32_bf16 v55, v107, v23, v55
    v_pk_mul_f32 v[56:57], v[80:81], v[80:81]
    v_pk_fma_f32 v[56:57], v[82:83], v[82:83], v[56:57]
    v_pk_fma_f32 v[56:57], v[84:85], v[84:85], v[56:57]
    v_pk_fma_f32 v[56:57], v[86:87], v[86:87], v[56:57]
    v_pk_fma_f32 v[56:57], v[88:89], v[88:89], v[56:57]
    v_pk_fma_f32 v[56:57], v[90:91], v[90:91], v[56:57]
    v_pk_fma_f32 v[56:57], v[92:93], v[92:93], v[56:57]
    v_pk_fma_f32 v[56:57], v[94:95], v[94:95], v[56:57]
    v_add_f32 v54, v54, v55
    v_add_f32 v56, v56, v57
    s_nop 0
    v_add_f32_dpp v54, v54, v54 row_ror:1 row_mask:0xf bank_mask:0xf
    v_add_f32_dpp v56, v56, v56 row_ror:1 row_mask:0xf bank_mask:0xf
    s_nop 0
    v_add_f32_dpp v54, v54, v54 row_ror:2 row_mask:0xf bank_mask:0xf
    v_add_f32_dpp v56, v56, v56 row_ror:2 row_mask:0xf bank_mask:0xf
    s_nop 0
    v_add_f32_dpp v54, v54, v54 row_ror:4 row_mask:0xf bank_mask:0xf
    v_add_f32_dpp v56, v56, v56 row_ror:4 row_mask:0xf bank_mask:0xf
    s_nop 0
    v_add_f32_dpp v54, v54, v54 row_ror:8 row_mask:0xf bank_mask:0xf
    v_add_f32_dpp v56, v56, v56 row_ror:8 row_mask:0xf bank_mask:0xf
    v_mov_b32 v58, v54
    v_mov_b32 v59, v56
    s_nop 0
    v_permlane16_swap_b32 v54, v58
    v_permlane16_swap_b32 v56, v59
    v_add_f32 v54, v54, v58
    v_add_f32 v56, v56, v59
    v_mul_f32 v55, 0x3b000000, v54
    v_mul_f32 v56, 0x3b000000, v56
    v_sub_f32 v54, v55, v52
    v_fma_f32 v56, -v54, v54, v56
    v_max_f32 v56, 0, v56
    v_cvt_pk_bf16_f32 v55, v55, v56
    v_lshlrev_b32 v58, 16, v55
    v_and_b32 v56, s62, v55
    v_add_f32 v56, 0x3727c5ac, v56
    v_cvt_pk_bf16_f32 v56, v56, v56
    v_lshlrev_b32 v56, 16, v56
    v_sqrt_f32 v56, v56
    v_and_b32 v55, 0xffff, v55
    v_cvt_pk_bf16_f32 v56, v56, v56
    v_and_b32 v56, s62, v56
    v_rcp_f32 v60, v56
    s_nop 0
    v_fma_f32 v57, -v56, v60, 1.0
    v_fma_f32 v60, v60, v57, v60
    v_or_b32 v62, v55, v56
    v_pk_add_f32 v[64:65], v[64:65], v[58:59] op_sel_hi:[1,0] neg_lo:[0,1] neg_hi:[0,1]
    v_pk_add_f32 v[66:67], v[66:67], v[58:59] op_sel_hi:[1,0] neg_lo:[0,1] neg_hi:[0,1]
    v_pk_add_f32 v[68:69], v[68:69], v[58:59] op_sel_hi:[1,0] neg_lo:[0,1] neg_hi:[0,1]
    v_pk_add_f32 v[70:71], v[70:71], v[58:59] op_sel_hi:[1,0] neg_lo:[0,1] neg_hi:[0,1]
    v_pk_add_f32 v[72:73], v[72:73], v[58:59] op_sel_hi:[1,0] neg_lo:[0,1] neg_hi:[0,1]
    v_pk_add_f32 v[74:75], v[74:75], v[58:59] op_sel_hi:[1,0] neg_lo:[0,1] neg_hi:[0,1]
    v_pk_add_f32 v[76:77], v[76:77], v[58:59] op_sel_hi:[1,0] neg_lo:[0,1] neg_hi:[0,1]
    v_pk_add_f32 v[78:79], v[78:79], v[58:59] op_sel_hi:[1,0] neg_lo:[0,1] neg_hi:[0,1]
    v_cvt_pk_bf16_f32 v44, v64, v65
    v_cvt_pk_bf16_f32 v45, v66, v67
    v_cvt_pk_bf16_f32 v46, v68, v69
    v_cvt_pk_bf16_f32 v47, v70, v71
    v_cvt_pk_bf16_f32 v48, v72, v73
    v_cvt_pk_bf16_f32 v49, v74, v75
    v_cvt_pk_bf16_f32 v50, v76, v77
    v_cvt_pk_bf16_f32 v51, v78, v79
    v_lshlrev_b32 v64, 16, v44
    v_and_b32 v65, s62, v44
    v_lshlrev_b32 v66, 16, v45
    v_and_b32 v67, s62, v45
    v_lshlrev_b32 v68, 16, v46
    v_and_b32 v69, s62, v46
    v_lshlrev_b32 v70, 16, v47
    v_and_b32 v71, s62, v47
    v_lshlrev_b32 v72, 16, v48
    v_and_b32 v73, s62, v48
    v_lshlrev_b32 v74, 16, v49
    v_and_b32 v75, s62, v49
    v_lshlrev_b32 v76, 16, v50
    v_and_b32 v77, s62, v50
    v_lshlrev_b32 v78, 16, v51
    v_and_b32 v79, s62, v51
    v_pk_mul_f32 v[64:65], v[64:65], v[60:61] op_sel_hi:[1,0]
    v_pk_mul_f32 v[66:67], v[66:67], v[60:61] op_sel_hi:[1,0]
    v_pk_mul_f32 v[68:69], v[68:69], v[60:61] op_sel_hi:[1,0]
    v_pk_mul_f32 v[70:71], v[70:71], v[60:61] op_sel_hi:[1,0]
    v_pk_mul_f32 v[72:73], v[72:73], v[60:61] op_sel_hi:[1,0]
    v_pk_mul_f32 v[74:75], v[74:75], v[60:61] op_sel_hi:[1,0]
    v_pk_mul_f32 v[76:77], v[76:77], v[60:61] op_sel_hi:[1,0]
    v_pk_mul_f32 v[78:79], v[78:79], v[60:61] op_sel_hi:[1,0]
    v_cvt_pk_bf16_f32 v44, v64, v65
    v_cvt_pk_bf16_f32 v45, v66, v67
    v_cvt_pk_bf16_f32 v46, v68, v69
    v_cvt_pk_bf16_f32 v47, v70, v71
    v_cvt_pk_bf16_f32 v48, v72, v73
    v_cvt_pk_bf16_f32 v49, v74, v75
    v_cvt_pk_bf16_f32 v50, v76, v77
    v_cvt_pk_bf16_f32 v51, v78, v79
    ds_write_b128 v2, v[44:47] offset:8320
    ds_write_b128 v2, v[48:51] offset:8832
    v_mov_b32 v54, 0
    v_mov_b32 v56, 0
    s_waitcnt vmcnt(1)
    v_dot2_f32_bf16 v54, v44, v24, v54
    v_dot2_f32_bf16 v56, v48, v28, v56
    v_dot2_f32_bf16 v54, v45, v25, v54
    v_dot2_f32_bf16 v56, v49, v29, v56
    v_dot2_f32_bf16 v54, v46, v26, v54
    v_dot2_f32_bf16 v56, v50, v30, v56
    v_dot2_f32_bf16 v54, v47, v27, v54
    v_dot2_f32_bf16 v56, v51, v31, v56
    s_nop 2
    v_add_f32 v54, v54, v56
    s_nop 1
    v_add_f32_dpp v54, v54, v54 row_ror:1 row_mask:0xf bank_mask:0xf
    s_nop 1
    v_add_f32_dpp v54, v54, v54 row_ror:2 row_mask:0xf bank_mask:0xf
    s_nop 1
    v_add_f32_dpp v54, v54, v54 row_ror:4 row_mask:0xf bank_mask:0xf
    s_nop 1
    v_add_f32_dpp v54, v54, v54 row_ror:8 row_mask:0xf bank_mask:0xf
    v_mov_b32 v58, v54
    s_nop 1
    v_permlane16_swap_b32 v54, v58
    v_add_f32 v54, v54, v58
    v_cvt_pk_bf16_f32 v54, v54, v54
    v_lshlrev_b32 v54, 16, v54
    v_ashrrev_i32 v55, 31, v54
    v_or_b32 v55, s63, v55
    v_xor_b32 v55, v54, v55
    v_bfi_b32 v54, s62, v55, v20
    s_mov_b32 exec_lo, 1
    s_mov_b32 exec_hi, 1
    ds_write_b32 v21, v54
    ds_write_b32 v22, v62
    s_mov_b64 exec, -1
    s_waitcnt lgkmcnt(0)
    s_barrier
    ds_read_b128 v[80:83], v4
    ds_read_b128 v[84:87], v4 offset:16
    ds_read_u16 v64, v3 offset:8320
    ds_read_u16 v65, v3 offset:9360
    ds_read_u16 v66, v3 offset:10400
    ds_read_u16 v67, v3 offset:11440
    ds_read_u16 v68, v3 offset:8576
    ds_read_u16 v69, v3 offset:9616
    ds_read_u16 v70, v3 offset:10656
    ds_read_u16 v71, v3 offset:11696
    ds_read_u16 v72, v3 offset:8832
    ds_read_u16 v73, v3 offset:9872
    ds_read_u16 v74, v3 offset:10912
    ds_read_u16 v75, v3 offset:11952
    ds_read_u16 v76, v3 offset:9088
    ds_read_u16 v77, v3 offset:10128
    ds_read_u16 v78, v3 offset:11168
    ds_read_u16 v79, v3 offset:12208
    s_waitcnt lgkmcnt(15)
    v_max_u32 v88, v80, v81
    v_min_u32 v89, v80, v81
    v_max_u32 v90, v82, v83
    v_min_u32 v91, v82, v83
    v_max_u32 v92, v84, v85
    v_min_u32 v93, v84, v85
    v_max_u32 v94, v86, v87
    v_min_u32 v95, v86, v87
    v_max_u32 v89, v89, v91
    v_med3_u32 v89, v88, v90, v89
    v_max_u32 v88, v88, v90
    v_max_u32 v89, v89, v93
    v_med3_u32 v89, v88, v92, v89
    v_max_u32 v88, v88, v92
    v_max_u32 v89, v89, v95
    v_med3_u32 v89, v88, v94, v89
    v_max_u32 v88, v88, v94
    v_cndmask_b32 v47, 0, v89, s[66:67]
    v_cndmask_b32 v47, v47, v88, s[64:65]
    s_waitcnt lgkmcnt(12)
    v_lshl_or_b32 v44, v65, 16, v64
    v_lshl_or_b32 v45, v67, 16, v66
    v_mov_b32 v46, s33
    global_store_dwordx4 v5, v[44:47], s[44:45] sc1
    s_waitcnt lgkmcnt(8)
    v_lshl_or_b32 v48, v69, 16, v68
    v_lshl_or_b32 v49, v71, 16, v70
    v_mov_b32 v50, s33
    v_mov_b32 v51, v47
    global_store_dwordx4 v5, v[48:51], s[46:47] sc1
    s_waitcnt lgkmcnt(4)
    v_lshl_or_b32 v52, v73, 16, v72
    v_lshl_or_b32 v53, v75, 16, v74
    v_mov_b32 v54, s33
    v_mov_b32 v55, v47
    global_store_dwordx4 v5, v[52:55], s[48:49] sc1
    s_waitcnt lgkmcnt(0)
    v_lshl_or_b32 v56, v77, 16, v76
    v_lshl_or_b32 v57, v79, 16, v78
    v_mov_b32 v58, s33
    v_mov_b32 v59, v47
    global_store_dwordx4 v5, v[56:59], s[50:51] sc1
    s_setprio 0
    s_mul_i32 s39, s32, 1536
    s_add_u32 s39, s39, 135632
    v_lshl_add_u32 v20, v1, 2, s39
    ds_read_b32 v60, v20 offset:0
    ds_read_b32 v61, v20 offset:256
    ds_read_b32 v62, v20 offset:512
    ds_read_b32 v63, v20 offset:768
    ds_read_b32 v64, v20 offset:1024
    ds_read_b32 v65, v20 offset:1280
    s_mul_i32 s41, s36, 34816
    s_lshl_b32 s43, s37, 8
    s_add_u32 s41, s41, s43
    s_mov_b32 m0, s41
    s_waitcnt lgkmcnt(0)
    v_cvt_pk_bf16_f32 v97, v64, -v65
    v_pk_mul_f32 v[80:81], v[62:63], v[62:63] op_sel_hi:[1,0]
    v_pk_fma_f32 v[80:81], v[62:63], v[62:63], v[80:81] op_sel:[1,1,0] op_sel_hi:[0,1,1] neg_lo:[1,0,0]
    v_pk_mul_f32 v[66:67], v[64:65], v[60:61] op_sel_hi:[1,0]
    v_pk_fma_f32 v[66:67], v[64:65], v[60:61], v[66:67] op_sel:[1,1,0] op_sel_hi:[0,1,1] neg_lo:[1,0,0]
    ds_write_addtid_b32 v97 offset:17408
    v_cvt_pk_bf16_f32 v98, v66, -v67
    v_pk_mul_f32 v[82:83], v[80:81], v[62:63] op_sel_hi:[1,0]
    v_pk_fma_f32 v[82:83], v[80:81], v[62:63], v[82:83] op_sel:[1,1,0] op_sel_hi:[0,1,1] neg_lo:[1,0,0]
    v_pk_mul_f32 v[68:69], v[66:67], v[60:61] op_sel_hi:[1,0]
    v_pk_fma_f32 v[68:69], v[66:67], v[60:61], v[68:69] op_sel:[1,1,0] op_sel_hi:[0,1,1] neg_lo:[1,0,0]
    ds_write_addtid_b32 v98 offset:17952
    v_cvt_pk_bf16_f32 v99, v68, -v69
    v_pk_mul_f32 v[84:85], v[80:81], v[80:81] op_sel_hi:[1,0]
    v_pk_fma_f32 v[84:85], v[80:81], v[80:81], v[84:85] op_sel:[1,1,0] op_sel_hi:[0,1,1] neg_lo:[1,0,0]
    v_pk_mul_f32 v[70:71], v[68:69], v[60:61] op_sel_hi:[1,0]
    v_pk_fma_f32 v[70:71], v[68:69], v[60:61], v[70:71] op_sel:[1,1,0] op_sel_hi:[0,1,1] neg_lo:[1,0,0]
    ds_write_addtid_b32 v99 offset:18496
    v_cvt_pk_bf16_f32 v96, v70, -v71
    v_pk_mul_f32 v[86:87], v[84:85], v[62:63] op_sel_hi:[1,0]
    v_pk_fma_f32 v[86:87], v[84:85], v[62:63], v[86:87] op_sel:[1,1,0] op_sel_hi:[0,1,1] neg_lo:[1,0,0]
    v_pk_mul_f32 v[72:73], v[70:71], v[60:61] op_sel_hi:[1,0]
    v_pk_fma_f32 v[72:73], v[70:71], v[60:61], v[72:73] op_sel:[1,1,0] op_sel_hi:[0,1,1] neg_lo:[1,0,0]
    ds_write_addtid_b32 v96 offset:19040
    v_cvt_pk_bf16_f32 v97, v72, -v73
    v_pk_mul_f32 v[88:89], v[84:85], v[80:81] op_sel_hi:[1,0]
    v_pk_fma_f32 v[88:89], v[84:85], v[80:81], v[88:89] op_sel:[1,1,0] op_sel_hi:[0,1,1] neg_lo:[1,0,0]
    v_pk_mul_f32 v[74:75], v[72:73], v[60:61] op_sel_hi:[1,0]
    v_pk_fma_f32 v[74:75], v[72:73], v[60:61], v[74:75] op_sel:[1,1,0] op_sel_hi:[0,1,1] neg_lo:[1,0,0]
    ds_write_addtid_b32 v97 offset:19584
    v_cvt_pk_bf16_f32 v98, v74, -v75
    v_pk_mul_f32 v[90:91], v[84:85], v[82:83] op_sel_hi:[1,0]
    v_pk_fma_f32 v[90:91], v[84:85], v[82:83], v[90:91] op_sel:[1,1,0] op_sel_hi:[0,1,1] neg_lo:[1,0,0]
    v_pk_mul_f32 v[76:77], v[74:75], v[60:61] op_sel_hi:[1,0]
    v_pk_fma_f32 v[76:77], v[74:75], v[60:61], v[76:77] op_sel:[1,1,0] op_sel_hi:[0,1,1] neg_lo:[1,0,0]
    ds_write_addtid_b32 v98 offset:20128
    v_cvt_pk_bf16_f32 v99, v76, -v77
    v_pk_mul_f32 v[92:93], v[84:85], v[84:85] op_sel_hi:[1,0]
    v_pk_fma_f32 v[92:93], v[84:85], v[84:85], v[92:93] op_sel:[1,1,0] op_sel_hi:[0,1,1] neg_lo:[1,0,0]
    v_pk_mul_f32 v[78:79], v[76:77], v[60:61] op_sel_hi:[1,0]
    v_pk_fma_f32 v[78:79], v[76:77], v[60:61], v[78:79] op_sel:[1,1,0] op_sel_hi:[0,1,1] neg_lo:[1,0,0]
    ds_write_addtid_b32 v99 offset:20672
    v_cvt_pk_bf16_f32 v96, v78, -v79
    v_pk_mul_f32 v[44:45], v[64:65], v[62:63] op_sel_hi:[1,0]
    v_pk_fma_f32 v[44:45], v[64:65], v[62:63], v[44:45] op_sel:[1,1,0] op_sel_hi:[0,1,1] neg_lo:[1,0,0]
    ds_write_addtid_b32 v96 offset:21216
    v_cvt_pk_bf16_f32 v97, v44, -v45
    v_pk_mul_f32 v[46:47], v[68:69], v[62:63] op_sel_hi:[1,0]
    v_pk_fma_f32 v[46:47], v[68:69], v[62:63], v[46:47] op_sel:[1,1,0] op_sel_hi:[0,1,1] neg_lo:[1,0,0]
    ds_write_addtid_b32 v97 offset:21760
    v_cvt_pk_bf16_f32 v98, v46, -v47
    v_pk_mul_f32 v[48:49], v[72:73], v[62:63] op_sel_hi:[1,0]
    v_pk_fma_f32 v[48:49], v[72:73], v[62:63], v[48:49] op_sel:[1,1,0] op_sel_hi:[0,1,1] neg_lo:[1,0,0]
    ds_write_addtid_b32 v98 offset:22304
    v_cvt_pk_bf16_f32 v99, v48, -v49
    v_pk_mul_f32 v[50:51], v[76:77], v[62:63] op_sel_hi:[1,0]
    v_pk_fma_f32 v[50:51], v[76:77], v[62:63], v[50:51] op_sel:[1,1,0] op_sel_hi:[0,1,1] neg_lo:[1,0,0]
    ds_write_addtid_b32 v99 offset:22848
    v_cvt_pk_bf16_f32 v96, v50, -v51
    v_pk_mul_f32 v[44:45], v[64:65], v[80:81] op_sel_hi:[1,0]
    v_pk_fma_f32 v[44:45], v[64:65], v[80:81], v[44:45] op_sel:[1,1,0] op_sel_hi:[0,1,1] neg_lo:[1,0,0]
    ds_write_addtid_b32 v96 offset:23392
    v_cvt_pk_bf16_f32 v97, v44, -v45
    v_pk_mul_f32 v[46:47], v[72:73], v[80:81] op_sel_hi:[1,0]
    v_pk_fma_f32 v[46:47], v[72:73], v[80:81], v[46:47] op_sel:[1,1,0] op_sel_hi:[0,1,1] neg_lo:[1,0,0]
    ds_write_addtid_b32 v97 offset:23936
    v_cvt_pk_bf16_f32 v98, v46, -v47
    v_pk_mul_f32 v[48:49], v[64:65], v[82:83] op_sel_hi:[1,0]
    v_pk_fma_f32 v[48:49], v[64:65], v[82:83], v[48:49] op_sel:[1,1,0] op_sel_hi:[0,1,1] neg_lo:[1,0,0]
    ds_write_addtid_b32 v98 offset:24480
    v_cvt_pk_bf16_f32 v99, v48, -v49
    v_pk_mul_f32 v[50:51], v[72:73], v[82:83] op_sel_hi:[1,0]
    v_pk_fma_f32 v[50:51], v[72:73], v[82:83], v[50:51] op_sel:[1,1,0] op_sel_hi:[0,1,1] neg_lo:[1,0,0]
    ds_write_addtid_b32 v99 offset:25024
    v_cvt_pk_bf16_f32 v96, v50, -v51
    v_pk_mul_f32 v[44:45], v[64:65], v[84:85] op_sel_hi:[1,0]
    v_pk_fma_f32 v[44:45], v[64:65], v[84:85], v[44:45] op_sel:[1,1,0] op_sel_hi:[0,1,1] neg_lo:[1,0,0]
    ds_write_addtid_b32 v96 offset:25568
    v_cvt_pk_bf16_f32 v97, v44, -v45
    v_pk_mul_f32 v[46:47], v[64:65], v[86:87] op_sel_hi:[1,0]
    v_pk_fma_f32 v[46:47], v[64:65], v[86:87], v[46:47] op_sel:[1,1,0] op_sel_hi:[0,1,1] neg_lo:[1,0,0]
    ds_write_addtid_b32 v97 offset:26112
    v_cvt_pk_bf16_f32 v98, v46, -v47
    v_pk_mul_f32 v[48:49], v[64:65], v[88:89] op_sel_hi:[1,0]
    v_pk_fma_f32 v[48:49], v[64:65], v[88:89], v[48:49] op_sel:[1,1,0] op_sel_hi:[0,1,1] neg_lo:[1,0,0]
    ds_write_addtid_b32 v98 offset:26656
    v_cvt_pk_bf16_f32 v99, v48, -v49
    v_pk_mul_f32 v[50:51], v[64:65], v[90:91] op_sel_hi:[1,0]
    v_pk_fma_f32 v[50:51], v[64:65], v[90:91], v[50:51] op_sel:[1,1,0] op_sel_hi:[0,1,1] neg_lo:[1,0,0]
    ds_write_addtid_b32 v99 offset:27200
    v_cvt_pk_bf16_f32 v96, v50, -v51
    v_pk_mul_f32 v[44:45], v[64:65], v[92:93] op_sel_hi:[1,0]
    v_pk_fma_f32 v[44:45], v[64:65], v[92:93], v[44:45] op_sel:[1,1,0] op_sel_hi:[0,1,1] neg_lo:[1,0,0]
    ds_write_addtid_b32 v96 offset:27744
    v_cvt_pk_bf16_f32 v97, v44, -v45
    ds_write_addtid_b32 v97 offset:28288
    s_waitcnt lgkmcnt(0)
    s_lshr_b32 s36, s32, 1
    s_and_b32 s37, s32, 1
    v_and_b32 v16, 15, v1
    v_lshrrev_b32 v17, 4, v1
    v_mul_u32_u24 v18, 544, v16
    v_lshl_add_u32 v18, v17, 4, v18
    s_mul_i32 s39, s36, 34816
    s_add_u32 s39, s39, 0
    v_add_u32 v6, s39, v18
    s_mul_i32 s40, s37, 8704
    s_add_u32 s40, s40, s39
    s_add_u32 s40, s40, 17408
    v_add_u32 v7, s40, v18
    v_lshrrev_b32 v18, 2, v16
    v_sub_u32 v18, 4, v18
    v_min_u32 v18, 3, v18
    v_add_u32 v19, 0xf8, v16
    v_cmp_gt_u32 vcc, 8, v16
    s_nop 1
    v_cndmask_b32 v19, v19, v16, vcc
    v_bfe_u32 v20, v16, 1, 1
    v_lshlrev_b32 v20, 6, v20
    v_and_b32 v53, 1, v16
    v_add3_u32 v20, v20, v53, 64
    v_add_u32 v20, 0x140, v20
    v_cmp_gt_u32 vcc, 12, v16
    s_nop 1
    v_cndmask_b32 v19, v20, v19, vcc
    s_cmp_eq_u32 s37, 0
    s_cbranch_scc1 L_kth0
    v_add_u32 v19, 16, v16
    v_lshlrev_b32 v19, 5, v19
    v_mov_b32 v18, 0
L_kth0:
    v_lshlrev_b32 v20, 2, v17
    v_lshlrev_b32 v20, v18, v20
    v_add_u32 v19, v19, v20
    s_mul_i32 s39, s36, 1408
    s_add_u32 s39, s39, 88672
    v_lshl_add_u32 v8, v19, 1, s39
    v_lshlrev_b32 v20, v18, 2
    v_add_u32 v9, v8, v20
    v_add_u32 v10, v9, v20
    v_add_u32 v11, v10, v20
    v_lshlrev_b32 v20, 4, v20
    v_add_u32 v12, v8, v20
    v_add_u32 v13, v9, v20
    v_add_u32 v14, v10, v20
    v_add_u32 v15, v11, v20
    s_barrier
    ds_read_b128 v[44:47], v7 offset:0
    ds_read_b128 v[48:51], v6 offset:0
    ds_read_b128 v[52:55], v6 offset:8704
    ds_read_b128 v[56:59], v7 offset:64
    ds_read_b128 v[60:63], v6 offset:64
    ds_read_b128 v[64:67], v6 offset:8768
    ds_read_b128 v[68:71], v7 offset:128
    ds_read_b128 v[72:75], v6 offset:128
    ds_read_b128 v[76:79], v6 offset:8832
    ds_read_b128 v[80:83], v7 offset:192
    ds_read_b128 v[84:87], v6 offset:192
    ds_read_b128 v[88:91], v6 offset:8896
    ds_read_b128 v[92:95], v7 offset:256
    ds_read_b128 v[96:99], v6 offset:256
    ds_read_b128 v[100:103], v6 offset:8960
    s_waitcnt lgkmcnt(12)
    v_mfma_f32_16x16x32_bf16 v[24:27], v[48:51], v[44:47], 0
    v_mfma_f32_16x16x32_bf16 v[28:31], v[52:55], v[44:47], 0
    ds_read_b128 v[104:107], v7 offset:320
    ds_read_b128 v[108:111], v6 offset:320
    ds_read_b128 v[112:115], v6 offset:9024
    s_waitcnt lgkmcnt(12)
    v_mfma_f32_16x16x32_bf16 v[24:27], v[60:63], v[56:59], v[24:27]
    v_mfma_f32_16x16x32_bf16 v[28:31], v[64:67], v[56:59], v[28:31]
    ds_read_b128 v[116:119], v7 offset:384
    ds_read_b128 v[120:123], v6 offset:384
    ds_read_b128 v[124:127], v6 offset:9088
    s_waitcnt lgkmcnt(12)
    v_mfma_f32_16x16x32_bf16 v[24:27], v[72:75], v[68:71], v[24:27]
    v_mfma_f32_16x16x32_bf16 v[28:31], v[76:79], v[68:71], v[28:31]
    ds_read_b128 v[128:131], v7 offset:448
    ds_read_b128 v[132:135], v6 offset:448
    ds_read_b128 v[136:139], v6 offset:9152
    s_waitcnt lgkmcnt(12)
    v_mfma_f32_16x16x32_bf16 v[24:27], v[84:87], v[80:83], v[24:27]
    v_mfma_f32_16x16x32_bf16 v[28:31], v[88:91], v[80:83], v[28:31]
    s_waitcnt lgkmcnt(9)
    v_mfma_f32_16x16x32_bf16 v[24:27], v[96:99], v[92:95], v[24:27]
    v_mfma_f32_16x16x32_bf16 v[28:31], v[100:103], v[92:95], v[28:31]
    s_waitcnt lgkmcnt(6)
    v_mfma_f32_16x16x32_bf16 v[24:27], v[108:111], v[104:107], v[24:27]
    v_mfma_f32_16x16x32_bf16 v[28:31], v[112:115], v[104:107], v[28:31]
    s_waitcnt lgkmcnt(3)
    v_mfma_f32_16x16x32_bf16 v[24:27], v[120:123], v[116:119], v[24:27]
    v_mfma_f32_16x16x32_bf16 v[28:31], v[124:127], v[116:119], v[28:31]
    s_waitcnt lgkmcnt(0)
    v_mfma_f32_16x16x32_bf16 v[24:27], v[132:135], v[128:131], v[24:27]
    v_mfma_f32_16x16x32_bf16 v[28:31], v[136:139], v[128:131], v[28:31]
    s_cmp_eq_u32 s37, 0
    s_cselect_b32 s39, 16, 5
    v_and_b32 v53, 15, v1
    v_cmp_gt_u32 vcc, s39, v53
    s_nop 2
    v_cvt_pk_bf16_f32 v24, v24, v25
    v_cvt_pk_bf16_f32 v26, v26, v27
    v_cvt_pk_bf16_f32 v28, v28, v29
    v_cvt_pk_bf16_f32 v30, v30, v31
    s_and_b64 exec, exec, vcc
    ds_write_b16 v8, v24
    ds_write_b16_d16_hi v9, v24
    ds_write_b16 v10, v26
    ds_write_b16_d16_hi v11, v26
    ds_write_b16 v12, v28
    ds_write_b16_d16_hi v13, v28
    ds_write_b16 v14, v30
    ds_write_b16_d16_hi v15, v30
    s_mov_b64 exec, -1
    s_waitcnt lgkmcnt(0)
    v_mov_b32 v20, 86388
    v_mov_b32 v21, 1
    s_mov_b64 exec, 1
    ds_add_u32 v20, v21
    s_mov_b64 exec, -1
    v_mov_b32 v20, 86388
    s_mov_b32 s41, 0
L_ktc_lw:
    ds_read_b32 v21, v20
    s_add_u32 s41, s41, 1
    s_cmp_gt_u32 s41, 1000000
    s_cbranch_scc1 L_ktc_lwd
    s_waitcnt lgkmcnt(0)
    v_cmp_gt_u32 vcc, 4, v21
    s_nop 0
    s_cbranch_vccz L_ktc_lwd
    s_branch L_ktc_lw
L_ktc_lwd:
    s_waitcnt lgkmcnt(0)
    s_cmp_lg_u32 s32, 0
    s_cbranch_scc1 L_nozero
    v_mov_b32 v44, 0
    v_mov_b32 v45, 0
    v_mov_b32 v46, 0
    v_mov_b32 v47, 0
    v_mul_u32_u24 v20, 171, v1
    v_lshrrev_b32 v20, 9, v20
    v_mul_u32_u24 v21, 3, v20
    v_sub_u32 v21, v1, v21
    v_mul_u32_u24 v20, 4160, v20
    v_lshl_add_u32 v20, v21, 4, v20
    s_mov_b32 exec_lo, 0xffffff
    s_mov_b32 exec_hi, 0
    ds_write_b128 v20, v[44:47] offset:4112
    s_mov_b64 exec, -1
L_nozero:
    s_cmp_lg_u32 s32, 0
    s_cbranch_scc1 L_nozsig
    s_waitcnt lgkmcnt(0)
    v_mov_b32 v20, 86416
    v_mov_b32 v21, 1
    s_mov_b64 exec, 1
    ds_add_u32 v20, v21
    s_mov_b64 exec, -1
L_nozsig:
    v_and_b32 v53, 15, v1
    v_lshrrev_b32 v54, 4, v1
    v_and_b32 v55, 3, v53
    v_mul_u32_u24 v55, 4160, v55
    v_lshrrev_b32 v56, 2, v53
    v_sub_u32 v56, v54, v56
    v_lshl_add_u32 v55, v56, 4, v55
    s_mul_i32 s39, s36, 16640
    s_add_u32 s39, s39, 64
    v_add_u32 v16, s39, v55
    v_and_b32 v55, 1, v53
    v_mul_u32_u24 v57, 4640, v55
    v_lshrrev_b32 v56, 1, v53
    v_lshl_add_u32 v57, v56, 6, v57
    v_lshl_add_u32 v57, v54, 4, v57
    s_mul_i32 s39, s36, 9280
    s_add_u32 s39, s39, 91984
    v_add_u32 v17, s39, v57
    v_lshl_add_u32 v56, v56, 2, v54
    v_lshlrev_b32 v19, 4, v56
    v_lshl_add_u32 v19, v55, 3, v19
    s_lshl_b32 s39, s36, 12
    s_add_u32 s39, s39, 135632
    v_add_u32 v19, s39, v19
    v_bfe_u32 v22, v0, 1, 1
    v_and_b32 v21, 1, v0
    v_lshrrev_b32 v20, 2, v0
    v_lshlrev_b32 v9, 12, v22
    v_lshl_add_u32 v9, v20, 4, v9
    v_lshl_add_u32 v9, v21, 3, v9
    v_add_u32 v9, 135632, v9
    v_and_b32 v10, 3, v0
    v_lshlrev_b32 v10, 4, v10
    v_mul_u32_u24 v21, 16384, v20
    v_add_u32 v10, v10, v21
    s_lshl_b32 s39, s3, 6
    s_add_u32 s39, s39, 0x580000
    s_add_u32 s44, s30, s39
    s_addc_u32 s45, s31, 0
    s_add_u32 s46, s44, 1048576
    s_addc_u32 s47, s45, 0
    s_add_u32 s48, s46, 1048576
    s_addc_u32 s49, s47, 0
    s_add_u32 s50, s48, 1048576
    s_addc_u32 s51, s49, 0
    v_mov_b32 v142, s33
    v_mov_b32 v143, 0
    v_mov_b32 v146, s33
    v_mov_b32 v147, 0
    v_mov_b32 v150, s33
    v_mov_b32 v151, 0
    v_mov_b32 v154, s33
    v_mov_b32 v155, 0
    v_mov_b32 v20, 86416
    s_mov_b32 s41, 0
L_kcc_lw:
    ds_read_b32 v21, v20
    s_add_u32 s41, s41, 1
    s_cmp_gt_u32 s41, 1000000
    s_cbranch_scc1 L_kcc_lwd
    s_waitcnt lgkmcnt(0)
    v_cmp_gt_u32 vcc, 5, v21
    s_nop 0
    s_cbranch_vccz L_kcc_lwd
    s_branch L_kcc_lw
L_kcc_lwd:
    s_waitcnt lgkmcnt(0)
    s_bitcmp1_b32 s32, 0
    s_cbranch_scc1 L_convB
    v_add_u32 v17, 0xfffffe40, v17
    ds_read_b128 v[44:47], v16 offset:4032
    ds_read_b128 v[48:51], v16 offset:3520
    ds_read_b128 v[52:55], v16 offset:3008
    ds_read_b128 v[56:59], v16 offset:2496
    ds_read_b128 v[60:63], v16 offset:1984
    ds_read_b128 v[64:67], v16 offset:1472
    ds_read_b128 v[68:71], v16 offset:960
    ds_read_b128 v[72:75], v16 offset:448
    s_waitcnt lgkmcnt(0)
    v_mov_b32 v20, 86424
    s_mov_b32 s41, 0
L_uA_lw:
    ds_read_b32 v21, v20
    s_add_u32 s41, s41, 1
    s_cmp_gt_u32 s41, 1000000
    s_cbranch_scc1 L_uA_lwd
    s_waitcnt lgkmcnt(0)
    v_cmp_gt_u32 vcc, 4, v21
    s_nop 0
    s_cbranch_vccz L_uA_lwd
    s_branch L_uA_lw
L_uA_lwd:
    s_waitcnt lgkmcnt(0)
    s_setprio 2
    ds_read_b128 v[104:107], v17 offset:4032
    ds_read_b128 v[100:103], v17 offset:3520
    ds_read_b128 v[84:87], v17 offset:1472
    ds_read_b128 v[96:99], v17 offset:3008
    ds_read_b128 v[80:83], v17 offset:960
    ds_read_b128 v[92:95], v17 offset:2496
    ds_read_b128 v[76:79], v17 offset:448
    ds_read_b128 v[88:91], v17 offset:1984
    s_waitcnt lgkmcnt(4)
    v_mfma_f32_16x16x32_bf16 v[108:111], v[44:47], v[104:107], 0
    ds_read_b128 v[104:107], v17 offset:3968
    v_mfma_f32_16x16x32_bf16 v[108:111], v[48:51], v[100:103], v[108:111]
    v_mfma_f32_16x16x32_bf16 v[112:115], v[44:47], v[100:103], 0
    ds_read_b128 v[100:103], v17 offset:3456
    v_mfma_f32_16x16x32_bf16 v[116:119], v[44:47], v[84:87], 0
    ds_read_b128 v[44:47], v16 offset:3968
    v_mfma_f32_16x16x32_bf16 v[108:111], v[52:55], v[96:99], v[108:111]
    v_mfma_f32_16x16x32_bf16 v[112:115], v[48:51], v[96:99], v[112:115]
    ds_read_b128 v[96:99], v17 offset:2944
    s_waitcnt lgkmcnt(4)
    v_mfma_f32_16x16x32_bf16 v[116:119], v[48:51], v[80:83], v[116:119]
    ds_read_b128 v[48:51], v16 offset:3456
    v_mfma_f32_16x16x32_bf16 v[108:111], v[56:59], v[92:95], v[108:111]
    v_mfma_f32_16x16x32_bf16 v[112:115], v[52:55], v[92:95], v[112:115]
    ds_read_b128 v[92:95], v17 offset:2432
    v_mfma_f32_16x16x32_bf16 v[116:119], v[52:55], v[76:79], v[116:119]
    ds_read_b128 v[52:55], v16 offset:2944
    v_mfma_f32_16x16x32_bf16 v[108:111], v[60:63], v[88:91], v[108:111]
    v_mfma_f32_16x16x32_bf16 v[112:115], v[56:59], v[88:91], v[112:115]
    ds_read_b128 v[56:59], v16 offset:2432
    v_mfma_f32_16x16x32_bf16 v[108:111], v[64:67], v[84:87], v[108:111]
    ds_read_b128 v[88:91], v17 offset:1920
    v_mfma_f32_16x16x32_bf16 v[112:115], v[60:63], v[84:87], v[112:115]
    ds_read_b128 v[84:87], v17 offset:1408
    v_mfma_f32_16x16x32_bf16 v[108:111], v[68:71], v[80:83], v[108:111]
    ds_read_b128 v[60:63], v16 offset:1920
    v_mfma_f32_16x16x32_bf16 v[112:115], v[64:67], v[80:83], v[112:115]
    ds_read_b128 v[80:83], v17 offset:896
    v_mfma_f32_16x16x32_bf16 v[108:111], v[72:75], v[76:79], v[108:111]
    ds_read_b128 v[64:67], v16 offset:1408
    v_mfma_f32_16x16x32_bf16 v[112:115], v[68:71], v[76:79], v[112:115]
    ds_read_b128 v[76:79], v17 offset:384
    s_waitcnt lgkmcnt(4)
    v_mfma_f32_16x16x32_bf16 v[108:111], v[44:47], v[104:107], v[108:111]
    ds_read_b128 v[68:71], v16 offset:896
    v_mfma_f32_16x16x32_bf16 v[108:111], v[48:51], v[100:103], v[108:111]
    ds_read_b128 v[72:75], v16 offset:384
    v_mfma_f32_16x16x32_bf16 v[112:115], v[44:47], v[100:103], v[112:115]
    ds_read_b128 v[104:107], v17 offset:3904
    v_mfma_f32_16x16x32_bf16 v[116:119], v[44:47], v[84:87], v[116:119]
    ds_read_b128 v[44:47], v16 offset:3904
    v_mfma_f32_16x16x32_bf16 v[108:111], v[52:55], v[96:99], v[108:111]
    ds_read_b128 v[100:103], v17 offset:3392
    v_mfma_f32_16x16x32_bf16 v[112:115], v[48:51], v[96:99], v[112:115]
    ds_read_b128 v[96:99], v17 offset:2880
    s_waitcnt lgkmcnt(6)
    v_mfma_f32_16x16x32_bf16 v[116:119], v[48:51], v[80:83], v[116:119]
    ds_read_b128 v[48:51], v16 offset:3392
    v_mfma_f32_16x16x32_bf16 v[108:111], v[56:59], v[92:95], v[108:111]
    v_mfma_f32_16x16x32_bf16 v[112:115], v[52:55], v[92:95], v[112:115]
    ds_read_b128 v[92:95], v17 offset:2368
    v_mfma_f32_16x16x32_bf16 v[116:119], v[52:55], v[76:79], v[116:119]
    ds_read_b128 v[52:55], v16 offset:2880
    v_mfma_f32_16x16x32_bf16 v[108:111], v[60:63], v[88:91], v[108:111]
    v_mfma_f32_16x16x32_bf16 v[112:115], v[56:59], v[88:91], v[112:115]
    ds_read_b128 v[56:59], v16 offset:2368
    v_mfma_f32_16x16x32_bf16 v[108:111], v[64:67], v[84:87], v[108:111]
    ds_read_b128 v[88:91], v17 offset:1856
    v_mfma_f32_16x16x32_bf16 v[112:115], v[60:63], v[84:87], v[112:115]
    ds_read_b128 v[84:87], v17 offset:1344
    s_waitcnt lgkmcnt(8)
    v_mfma_f32_16x16x32_bf16 v[108:111], v[68:71], v[80:83], v[108:111]
    ds_read_b128 v[60:63], v16 offset:1856
    v_mfma_f32_16x16x32_bf16 v[112:115], v[64:67], v[80:83], v[112:115]
    ds_read_b128 v[80:83], v17 offset:832
    v_mfma_f32_16x16x32_bf16 v[108:111], v[72:75], v[76:79], v[108:111]
    ds_read_b128 v[64:67], v16 offset:1344
    v_mfma_f32_16x16x32_bf16 v[112:115], v[68:71], v[76:79], v[112:115]
    ds_read_b128 v[76:79], v17 offset:320
    v_mfma_f32_16x16x32_bf16 v[108:111], v[44:47], v[104:107], v[108:111]
    ds_read_b128 v[68:71], v16 offset:832
    s_waitcnt lgkmcnt(5)
    v_mfma_f32_16x16x32_bf16 v[108:111], v[48:51], v[100:103], v[108:111]
    ds_read_b128 v[72:75], v16 offset:320
    v_mfma_f32_16x16x32_bf16 v[112:115], v[44:47], v[100:103], v[112:115]
    ds_read_b128 v[104:107], v17 offset:3840
    v_mfma_f32_16x16x32_bf16 v[116:119], v[44:47], v[84:87], v[116:119]
    ds_read_b128 v[44:47], v16 offset:3840
    v_mfma_f32_16x16x32_bf16 v[108:111], v[52:55], v[96:99], v[108:111]
    ds_read_b128 v[100:103], v17 offset:3328
    v_mfma_f32_16x16x32_bf16 v[112:115], v[48:51], v[96:99], v[112:115]
    ds_read_b128 v[96:99], v17 offset:2816
    s_waitcnt lgkmcnt(6)
    v_mfma_f32_16x16x32_bf16 v[116:119], v[48:51], v[80:83], v[116:119]
    ds_read_b128 v[48:51], v16 offset:3328
    v_mfma_f32_16x16x32_bf16 v[108:111], v[56:59], v[92:95], v[108:111]
    v_mfma_f32_16x16x32_bf16 v[112:115], v[52:55], v[92:95], v[112:115]
    ds_read_b128 v[92:95], v17 offset:2304
    v_mfma_f32_16x16x32_bf16 v[116:119], v[52:55], v[76:79], v[116:119]
    ds_read_b128 v[52:55], v16 offset:2816
    v_mfma_f32_16x16x32_bf16 v[108:111], v[60:63], v[88:91], v[108:111]
    v_mfma_f32_16x16x32_bf16 v[112:115], v[56:59], v[88:91], v[112:115]
    ds_read_b128 v[56:59], v16 offset:2304
    v_mfma_f32_16x16x32_bf16 v[108:111], v[64:67], v[84:87], v[108:111]
    ds_read_b128 v[88:91], v17 offset:1792
    v_mfma_f32_16x16x32_bf16 v[112:115], v[60:63], v[84:87], v[112:115]
    ds_read_b128 v[84:87], v17 offset:1280
    s_waitcnt lgkmcnt(8)
    v_mfma_f32_16x16x32_bf16 v[108:111], v[68:71], v[80:83], v[108:111]
    ds_read_b128 v[60:63], v16 offset:1792
    v_mfma_f32_16x16x32_bf16 v[112:115], v[64:67], v[80:83], v[112:115]
    ds_read_b128 v[80:83], v17 offset:768
    v_mfma_f32_16x16x32_bf16 v[108:111], v[72:75], v[76:79], v[108:111]
    ds_read_b128 v[64:67], v16 offset:1280
    v_mfma_f32_16x16x32_bf16 v[112:115], v[68:71], v[76:79], v[112:115]
    ds_read_b128 v[76:79], v17 offset:256
    v_mfma_f32_16x16x32_bf16 v[108:111], v[44:47], v[104:107], v[108:111]
    ds_read_b128 v[68:71], v16 offset:768
    s_waitcnt lgkmcnt(5)
    v_mfma_f32_16x16x32_bf16 v[108:111], v[48:51], v[100:103], v[108:111]
    ds_read_b128 v[72:75], v16 offset:256
    v_mfma_f32_16x16x32_bf16 v[112:115], v[44:47], v[100:103], v[112:115]
    ds_read_b128 v[104:107], v17 offset:3776
    v_mfma_f32_16x16x32_bf16 v[116:119], v[44:47], v[84:87], v[116:119]
    ds_read_b128 v[44:47], v16 offset:3776
    v_mfma_f32_16x16x32_bf16 v[108:111], v[52:55], v[96:99], v[108:111]
    ds_read_b128 v[100:103], v17 offset:3264
    v_mfma_f32_16x16x32_bf16 v[112:115], v[48:51], v[96:99], v[112:115]
    ds_read_b128 v[96:99], v17 offset:2752
    s_waitcnt lgkmcnt(6)
    v_mfma_f32_16x16x32_bf16 v[116:119], v[48:51], v[80:83], v[116:119]
    ds_read_b128 v[48:51], v16 offset:3264
    v_mfma_f32_16x16x32_bf16 v[108:111], v[56:59], v[92:95], v[108:111]
    v_mfma_f32_16x16x32_bf16 v[112:115], v[52:55], v[92:95], v[112:115]
    ds_read_b128 v[92:95], v17 offset:2240
    v_mfma_f32_16x16x32_bf16 v[116:119], v[52:55], v[76:79], v[116:119]
    ds_read_b128 v[52:55], v16 offset:2752
    v_mfma_f32_16x16x32_bf16 v[108:111], v[60:63], v[88:91], v[108:111]
    v_mfma_f32_16x16x32_bf16 v[112:115], v[56:59], v[88:91], v[112:115]
    ds_read_b128 v[56:59], v16 offset:2240
    v_mfma_f32_16x16x32_bf16 v[108:111], v[64:67], v[84:87], v[108:111]
    ds_read_b128 v[88:91], v17 offset:1728
    v_mfma_f32_16x16x32_bf16 v[112:115], v[60:63], v[84:87], v[112:115]
    ds_read_b128 v[84:87], v17 offset:1216
    s_waitcnt lgkmcnt(8)
    v_mfma_f32_16x16x32_bf16 v[108:111], v[68:71], v[80:83], v[108:111]
    ds_read_b128 v[60:63], v16 offset:1728
    v_mfma_f32_16x16x32_bf16 v[112:115], v[64:67], v[80:83], v[112:115]
    ds_read_b128 v[80:83], v17 offset:704
    v_mfma_f32_16x16x32_bf16 v[108:111], v[72:75], v[76:79], v[108:111]
    ds_read_b128 v[64:67], v16 offset:1216
    v_mfma_f32_16x16x32_bf16 v[112:115], v[68:71], v[76:79], v[112:115]
    ds_read_b128 v[76:79], v17 offset:192
    v_mfma_f32_16x16x32_bf16 v[108:111], v[44:47], v[104:107], v[108:111]
    ds_read_b128 v[68:71], v16 offset:704
    s_waitcnt lgkmcnt(5)
    v_mfma_f32_16x16x32_bf16 v[108:111], v[48:51], v[100:103], v[108:111]
    ds_read_b128 v[72:75], v16 offset:192
    v_mfma_f32_16x16x32_bf16 v[112:115], v[44:47], v[100:103], v[112:115]
    ds_read_b128 v[104:107], v17 offset:3712
    v_mfma_f32_16x16x32_bf16 v[116:119], v[44:47], v[84:87], v[116:119]
    ds_read_b128 v[44:47], v16 offset:3712
    v_mfma_f32_16x16x32_bf16 v[108:111], v[52:55], v[96:99], v[108:111]
    ds_read_b128 v[100:103], v17 offset:3200
    v_mfma_f32_16x16x32_bf16 v[112:115], v[48:51], v[96:99], v[112:115]
    ds_read_b128 v[96:99], v17 offset:2688
    s_waitcnt lgkmcnt(6)
    v_mfma_f32_16x16x32_bf16 v[116:119], v[48:51], v[80:83], v[116:119]
    ds_read_b128 v[48:51], v16 offset:3200
    v_mfma_f32_16x16x32_bf16 v[108:111], v[56:59], v[92:95], v[108:111]
    v_mfma_f32_16x16x32_bf16 v[112:115], v[52:55], v[92:95], v[112:115]
    ds_read_b128 v[92:95], v17 offset:2176
    v_mfma_f32_16x16x32_bf16 v[116:119], v[52:55], v[76:79], v[116:119]
    ds_read_b128 v[52:55], v16 offset:2688
    v_mfma_f32_16x16x32_bf16 v[108:111], v[60:63], v[88:91], v[108:111]
    v_mfma_f32_16x16x32_bf16 v[112:115], v[56:59], v[88:91], v[112:115]
    ds_read_b128 v[56:59], v16 offset:2176
    v_mfma_f32_16x16x32_bf16 v[108:111], v[64:67], v[84:87], v[108:111]
    ds_read_b128 v[88:91], v17 offset:1664
    v_mfma_f32_16x16x32_bf16 v[112:115], v[60:63], v[84:87], v[112:115]
    ds_read_b128 v[84:87], v17 offset:1152
    s_waitcnt lgkmcnt(8)
    v_mfma_f32_16x16x32_bf16 v[108:111], v[68:71], v[80:83], v[108:111]
    ds_read_b128 v[60:63], v16 offset:1664
    v_mfma_f32_16x16x32_bf16 v[112:115], v[64:67], v[80:83], v[112:115]
    ds_read_b128 v[80:83], v17 offset:640
    v_mfma_f32_16x16x32_bf16 v[108:111], v[72:75], v[76:79], v[108:111]
    ds_read_b128 v[64:67], v16 offset:1152
    v_mfma_f32_16x16x32_bf16 v[112:115], v[68:71], v[76:79], v[112:115]
    ds_read_b128 v[76:79], v17 offset:128
    v_mfma_f32_16x16x32_bf16 v[108:111], v[44:47], v[104:107], v[108:111]
    ds_read_b128 v[68:71], v16 offset:640
    s_waitcnt lgkmcnt(5)
    v_mfma_f32_16x16x32_bf16 v[108:111], v[48:51], v[100:103], v[108:111]
    ds_read_b128 v[72:75], v16 offset:128
    v_mfma_f32_16x16x32_bf16 v[112:115], v[44:47], v[100:103], v[112:115]
    ds_read_b128 v[104:107], v17 offset:3648
    v_mfma_f32_16x16x32_bf16 v[116:119], v[44:47], v[84:87], v[116:119]
    ds_read_b128 v[44:47], v16 offset:3648
    v_mfma_f32_16x16x32_bf16 v[108:111], v[52:55], v[96:99], v[108:111]
    ds_read_b128 v[100:103], v17 offset:3136
    v_mfma_f32_16x16x32_bf16 v[112:115], v[48:51], v[96:99], v[112:115]
    ds_read_b128 v[96:99], v17 offset:2624
    s_waitcnt lgkmcnt(6)
    v_mfma_f32_16x16x32_bf16 v[116:119], v[48:51], v[80:83], v[116:119]
    ds_read_b128 v[48:51], v16 offset:3136
    v_mfma_f32_16x16x32_bf16 v[108:111], v[56:59], v[92:95], v[108:111]
    v_mfma_f32_16x16x32_bf16 v[112:115], v[52:55], v[92:95], v[112:115]
    ds_read_b128 v[92:95], v17 offset:2112
    v_mfma_f32_16x16x32_bf16 v[116:119], v[52:55], v[76:79], v[116:119]
    ds_read_b128 v[52:55], v16 offset:2624
    v_mfma_f32_16x16x32_bf16 v[108:111], v[60:63], v[88:91], v[108:111]
    v_mfma_f32_16x16x32_bf16 v[112:115], v[56:59], v[88:91], v[112:115]
    ds_read_b128 v[56:59], v16 offset:2112
    v_mfma_f32_16x16x32_bf16 v[108:111], v[64:67], v[84:87], v[108:111]
    ds_read_b128 v[88:91], v17 offset:1600
    v_mfma_f32_16x16x32_bf16 v[112:115], v[60:63], v[84:87], v[112:115]
    ds_read_b128 v[84:87], v17 offset:1088
    s_waitcnt lgkmcnt(8)
    v_mfma_f32_16x16x32_bf16 v[108:111], v[68:71], v[80:83], v[108:111]
    ds_read_b128 v[60:63], v16 offset:1600
    v_mfma_f32_16x16x32_bf16 v[112:115], v[64:67], v[80:83], v[112:115]
    ds_read_b128 v[80:83], v17 offset:576
    v_mfma_f32_16x16x32_bf16 v[108:111], v[72:75], v[76:79], v[108:111]
    ds_read_b128 v[64:67], v16 offset:1088
    v_mfma_f32_16x16x32_bf16 v[112:115], v[68:71], v[76:79], v[112:115]
    ds_read_b128 v[76:79], v17 offset:64
    v_mfma_f32_16x16x32_bf16 v[108:111], v[44:47], v[104:107], v[108:111]
    ds_read_b128 v[68:71], v16 offset:576
    s_waitcnt lgkmcnt(5)
    v_mfma_f32_16x16x32_bf16 v[108:111], v[48:51], v[100:103], v[108:111]
    ds_read_b128 v[72:75], v16 offset:64
    v_mfma_f32_16x16x32_bf16 v[112:115], v[44:47], v[100:103], v[112:115]
    ds_read_b128 v[104:107], v17 offset:3584
    v_mfma_f32_16x16x32_bf16 v[116:119], v[44:47], v[84:87], v[116:119]
    ds_read_b128 v[44:47], v16 offset:3584
    v_mfma_f32_16x16x32_bf16 v[108:111], v[52:55], v[96:99], v[108:111]
    ds_read_b128 v[100:103], v17 offset:3072
    v_mfma_f32_16x16x32_bf16 v[112:115], v[48:51], v[96:99], v[112:115]
    ds_read_b128 v[96:99], v17 offset:2560
    s_waitcnt lgkmcnt(6)
    v_mfma_f32_16x16x32_bf16 v[116:119], v[48:51], v[80:83], v[116:119]
    ds_read_b128 v[48:51], v16 offset:3072
    v_mfma_f32_16x16x32_bf16 v[108:111], v[56:59], v[92:95], v[108:111]
    v_mfma_f32_16x16x32_bf16 v[112:115], v[52:55], v[92:95], v[112:115]
    ds_read_b128 v[92:95], v17 offset:2048
    v_mfma_f32_16x16x32_bf16 v[116:119], v[52:55], v[76:79], v[116:119]
    ds_read_b128 v[52:55], v16 offset:2560
    v_mfma_f32_16x16x32_bf16 v[108:111], v[60:63], v[88:91], v[108:111]
    v_mfma_f32_16x16x32_bf16 v[112:115], v[56:59], v[88:91], v[112:115]
    ds_read_b128 v[56:59], v16 offset:2048
    v_mfma_f32_16x16x32_bf16 v[108:111], v[64:67], v[84:87], v[108:111]
    ds_read_b128 v[88:91], v17 offset:1536
    v_mfma_f32_16x16x32_bf16 v[112:115], v[60:63], v[84:87], v[112:115]
    ds_read_b128 v[84:87], v17 offset:1024
    s_waitcnt lgkmcnt(8)
    v_mfma_f32_16x16x32_bf16 v[108:111], v[68:71], v[80:83], v[108:111]
    ds_read_b128 v[60:63], v16 offset:1536
    v_mfma_f32_16x16x32_bf16 v[112:115], v[64:67], v[80:83], v[112:115]
    ds_read_b128 v[80:83], v17 offset:512
    v_mfma_f32_16x16x32_bf16 v[108:111], v[72:75], v[76:79], v[108:111]
    ds_read_b128 v[64:67], v16 offset:1024
    v_mfma_f32_16x16x32_bf16 v[112:115], v[68:71], v[76:79], v[112:115]
    ds_read_b128 v[76:79], v17 offset:0
    v_mfma_f32_16x16x32_bf16 v[108:111], v[44:47], v[104:107], v[108:111]
    ds_read_b128 v[68:71], v16 offset:512
    s_waitcnt lgkmcnt(5)
    v_mfma_f32_16x16x32_bf16 v[108:111], v[48:51], v[100:103], v[108:111]
    ds_read_b128 v[72:75], v16 offset:0
    v_mfma_f32_16x16x32_bf16 v[112:115], v[44:47], v[100:103], v[112:115]
    v_mfma_f32_16x16x32_bf16 v[116:119], v[44:47], v[84:87], v[116:119]
    v_mfma_f32_16x16x32_bf16 v[108:111], v[52:55], v[96:99], v[108:111]
    v_mfma_f32_16x16x32_bf16 v[112:115], v[48:51], v[96:99], v[112:115]
    s_waitcnt lgkmcnt(2)
    v_mfma_f32_16x16x32_bf16 v[116:119], v[48:51], v[80:83], v[116:119]
    v_mfma_f32_16x16x32_bf16 v[108:111], v[56:59], v[92:95], v[108:111]
    v_mfma_f32_16x16x32_bf16 v[112:115], v[52:55], v[92:95], v[112:115]
    v_mfma_f32_16x16x32_bf16 v[116:119], v[52:55], v[76:79], v[116:119]
    v_mfma_f32_16x16x32_bf16 v[108:111], v[60:63], v[88:91], v[108:111]
    v_mfma_f32_16x16x32_bf16 v[112:115], v[56:59], v[88:91], v[112:115]
    v_mfma_f32_16x16x32_bf16 v[108:111], v[64:67], v[84:87], v[108:111]
    v_mfma_f32_16x16x32_bf16 v[112:115], v[60:63], v[84:87], v[112:115]
    s_waitcnt lgkmcnt(0)
    v_mfma_f32_16x16x32_bf16 v[108:111], v[68:71], v[80:83], v[108:111]
    v_mfma_f32_16x16x32_bf16 v[112:115], v[64:67], v[80:83], v[112:115]
    v_mfma_f32_16x16x32_bf16 v[108:111], v[72:75], v[76:79], v[108:111]
    v_mfma_f32_16x16x32_bf16 v[112:115], v[68:71], v[76:79], v[112:115]
    v_cvt_pk_bf16_f32 v132, v116, v117
    v_cvt_pk_bf16_f32 v133, v118, v119
    ds_write_b64 v19, v[132:133] offset:1024
    s_nop 3
    v_cvt_pk_bf16_f32 v128, v108, v109
    v_cvt_pk_bf16_f32 v129, v110, v111
    ds_write_b64 v19, v[128:129] offset:3584
    v_cvt_pk_bf16_f32 v130, v112, v113
    v_cvt_pk_bf16_f32 v131, v114, v115
    ds_write_b64 v19, v[130:131] offset:3072
    s_branch L_convdone
L_convB:
    v_add_u32 v17, 0xfffffe40, v17
    ds_read_b128 v[44:47], v16 offset:4032
    ds_read_b128 v[48:51], v16 offset:3520
    ds_read_b128 v[52:55], v16 offset:3008
    ds_read_b128 v[56:59], v16 offset:2496
    ds_read_b128 v[60:63], v16 offset:1984
    ds_read_b128 v[64:67], v16 offset:1472
    s_waitcnt lgkmcnt(0)
    v_mov_b32 v20, 86424
    s_mov_b32 s41, 0
L_uB_lw:
    ds_read_b32 v21, v20
    s_add_u32 s41, s41, 1
    s_cmp_gt_u32 s41, 1000000
    s_cbranch_scc1 L_uB_lwd
    s_waitcnt lgkmcnt(0)
    v_cmp_gt_u32 vcc, 4, v21
    s_nop 0
    s_cbranch_vccz L_uB_lwd
    s_branch L_uB_lw
L_uB_lwd:
    s_waitcnt lgkmcnt(0)
    s_setprio 2
    ds_read_b128 v[96:99], v17 offset:3008
    ds_read_b128 v[92:95], v17 offset:2496
    ds_read_b128 v[88:91], v17 offset:1984
    ds_read_b128 v[80:83], v17 offset:960
    ds_read_b128 v[76:79], v17 offset:448
    ds_read_b128 v[84:87], v17 offset:1472
    s_waitcnt lgkmcnt(2)
    v_mfma_f32_16x16x32_bf16 v[108:111], v[44:47], v[96:99], 0
    ds_read_b128 v[96:99], v17 offset:2944
    v_mfma_f32_16x16x32_bf16 v[108:111], v[48:51], v[92:95], v[108:111]
    v_mfma_f32_16x16x32_bf16 v[112:115], v[44:47], v[92:95], 0
    ds_read_b128 v[92:95], v17 offset:2432
    v_mfma_f32_16x16x32_bf16 v[116:119], v[44:47], v[88:91], 0
    v_mfma_f32_16x16x32_bf16 v[120:123], v[44:47], v[80:83], 0
    s_waitcnt lgkmcnt(2)
    v_mfma_f32_16x16x32_bf16 v[124:127], v[44:47], v[76:79], 0
    ds_read_b128 v[44:47], v16 offset:3968
    v_mfma_f32_16x16x32_bf16 v[108:111], v[52:55], v[88:91], v[108:111]
    v_mfma_f32_16x16x32_bf16 v[112:115], v[48:51], v[88:91], v[112:115]
    ds_read_b128 v[88:91], v17 offset:1920
    v_mfma_f32_16x16x32_bf16 v[116:119], v[48:51], v[84:87], v[116:119]
    v_mfma_f32_16x16x32_bf16 v[120:123], v[48:51], v[76:79], v[120:123]
    ds_read_b128 v[48:51], v16 offset:3456
    v_mfma_f32_16x16x32_bf16 v[108:111], v[56:59], v[84:87], v[108:111]
    v_mfma_f32_16x16x32_bf16 v[112:115], v[52:55], v[84:87], v[112:115]
    ds_read_b128 v[84:87], v17 offset:1408
    v_mfma_f32_16x16x32_bf16 v[116:119], v[52:55], v[80:83], v[116:119]
    ds_read_b128 v[52:55], v16 offset:2944
    v_mfma_f32_16x16x32_bf16 v[108:111], v[60:63], v[80:83], v[108:111]
    v_mfma_f32_16x16x32_bf16 v[112:115], v[56:59], v[80:83], v[112:115]
    ds_read_b128 v[80:83], v17 offset:896
    v_mfma_f32_16x16x32_bf16 v[116:119], v[56:59], v[76:79], v[116:119]
    ds_read_b128 v[56:59], v16 offset:2432
    v_mfma_f32_16x16x32_bf16 v[108:111], v[64:67], v[76:79], v[108:111]
    ds_read_b128 v[64:67], v16 offset:1408
    v_mfma_f32_16x16x32_bf16 v[112:115], v[60:63], v[76:79], v[112:115]
    ds_read_b128 v[76:79], v17 offset:384
    s_waitcnt lgkmcnt(6)
    v_mfma_f32_16x16x32_bf16 v[108:111], v[44:47], v[96:99], v[108:111]
    ds_read_b128 v[60:63], v16 offset:1920
    v_mfma_f32_16x16x32_bf16 v[108:111], v[48:51], v[92:95], v[108:111]
    ds_read_b128 v[96:99], v17 offset:2880
    v_mfma_f32_16x16x32_bf16 v[112:115], v[44:47], v[92:95], v[112:115]
    ds_read_b128 v[92:95], v17 offset:2368
    v_mfma_f32_16x16x32_bf16 v[116:119], v[44:47], v[88:91], v[116:119]
    s_waitcnt lgkmcnt(3)
    v_mfma_f32_16x16x32_bf16 v[120:123], v[44:47], v[80:83], v[120:123]
    v_mfma_f32_16x16x32_bf16 v[124:127], v[44:47], v[76:79], v[124:127]
    ds_read_b128 v[44:47], v16 offset:3904
    v_mfma_f32_16x16x32_bf16 v[108:111], v[52:55], v[88:91], v[108:111]
    v_mfma_f32_16x16x32_bf16 v[112:115], v[48:51], v[88:91], v[112:115]
    ds_read_b128 v[88:91], v17 offset:1856
    v_mfma_f32_16x16x32_bf16 v[116:119], v[48:51], v[84:87], v[116:119]
    v_mfma_f32_16x16x32_bf16 v[120:123], v[48:51], v[76:79], v[120:123]
    ds_read_b128 v[48:51], v16 offset:3392
    v_mfma_f32_16x16x32_bf16 v[108:111], v[56:59], v[84:87], v[108:111]
    v_mfma_f32_16x16x32_bf16 v[112:115], v[52:55], v[84:87], v[112:115]
    ds_read_b128 v[84:87], v17 offset:1344
    v_mfma_f32_16x16x32_bf16 v[116:119], v[52:55], v[80:83], v[116:119]
    ds_read_b128 v[52:55], v16 offset:2880
    s_waitcnt lgkmcnt(7)
    v_mfma_f32_16x16x32_bf16 v[108:111], v[60:63], v[80:83], v[108:111]
    v_mfma_f32_16x16x32_bf16 v[112:115], v[56:59], v[80:83], v[112:115]
    ds_read_b128 v[80:83], v17 offset:832
    v_mfma_f32_16x16x32_bf16 v[116:119], v[56:59], v[76:79], v[116:119]
    ds_read_b128 v[56:59], v16 offset:2368
    v_mfma_f32_16x16x32_bf16 v[108:111], v[64:67], v[76:79], v[108:111]
    ds_read_b128 v[64:67], v16 offset:1344
    v_mfma_f32_16x16x32_bf16 v[112:115], v[60:63], v[76:79], v[112:115]
    ds_read_b128 v[76:79], v17 offset:320
    s_waitcnt lgkmcnt(6)
    v_mfma_f32_16x16x32_bf16 v[108:111], v[44:47], v[96:99], v[108:111]
    ds_read_b128 v[60:63], v16 offset:1856
    v_mfma_f32_16x16x32_bf16 v[108:111], v[48:51], v[92:95], v[108:111]
    ds_read_b128 v[96:99], v17 offset:2816
    v_mfma_f32_16x16x32_bf16 v[112:115], v[44:47], v[92:95], v[112:115]
    ds_read_b128 v[92:95], v17 offset:2304
    v_mfma_f32_16x16x32_bf16 v[116:119], v[44:47], v[88:91], v[116:119]
    s_waitcnt lgkmcnt(3)
    v_mfma_f32_16x16x32_bf16 v[120:123], v[44:47], v[80:83], v[120:123]
    v_mfma_f32_16x16x32_bf16 v[124:127], v[44:47], v[76:79], v[124:127]
    ds_read_b128 v[44:47], v16 offset:3840
    v_mfma_f32_16x16x32_bf16 v[108:111], v[52:55], v[88:91], v[108:111]
    v_mfma_f32_16x16x32_bf16 v[112:115], v[48:51], v[88:91], v[112:115]
    ds_read_b128 v[88:91], v17 offset:1792
    v_mfma_f32_16x16x32_bf16 v[116:119], v[48:51], v[84:87], v[116:119]
    v_mfma_f32_16x16x32_bf16 v[120:123], v[48:51], v[76:79], v[120:123]
    ds_read_b128 v[48:51], v16 offset:3328
    v_mfma_f32_16x16x32_bf16 v[108:111], v[56:59], v[84:87], v[108:111]
    v_mfma_f32_16x16x32_bf16 v[112:115], v[52:55], v[84:87], v[112:115]
    ds_read_b128 v[84:87], v17 offset:1280
    v_mfma_f32_16x16x32_bf16 v[116:119], v[52:55], v[80:83], v[116:119]
    ds_read_b128 v[52:55], v16 offset:2816
    s_waitcnt lgkmcnt(7)
    v_mfma_f32_16x16x32_bf16 v[108:111], v[60:63], v[80:83], v[108:111]
    v_mfma_f32_16x16x32_bf16 v[112:115], v[56:59], v[80:83], v[112:115]
    ds_read_b128 v[80:83], v17 offset:768
    v_mfma_f32_16x16x32_bf16 v[116:119], v[56:59], v[76:79], v[116:119]
    ds_read_b128 v[56:59], v16 offset:2304
    v_mfma_f32_16x16x32_bf16 v[108:111], v[64:67], v[76:79], v[108:111]
    ds_read_b128 v[64:67], v16 offset:1280
    v_mfma_f32_16x16x32_bf16 v[112:115], v[60:63], v[76:79], v[112:115]
    ds_read_b128 v[76:79], v17 offset:256
    s_waitcnt lgkmcnt(6)
    v_mfma_f32_16x16x32_bf16 v[108:111], v[44:47], v[96:99], v[108:111]
    ds_read_b128 v[60:63], v16 offset:1792
    v_mfma_f32_16x16x32_bf16 v[108:111], v[48:51], v[92:95], v[108:111]
    ds_read_b128 v[96:99], v17 offset:2752
    v_mfma_f32_16x16x32_bf16 v[112:115], v[44:47], v[92:95], v[112:115]
    ds_read_b128 v[92:95], v17 offset:2240
    v_mfma_f32_16x16x32_bf16 v[116:119], v[44:47], v[88:91], v[116:119]
    s_waitcnt lgkmcnt(3)
    v_mfma_f32_16x16x32_bf16 v[120:123], v[44:47], v[80:83], v[120:123]
    v_mfma_f32_16x16x32_bf16 v[124:127], v[44:47], v[76:79], v[124:127]
    ds_read_b128 v[44:47], v16 offset:3776
    v_mfma_f32_16x16x32_bf16 v[108:111], v[52:55], v[88:91], v[108:111]
    v_mfma_f32_16x16x32_bf16 v[112:115], v[48:51], v[88:91], v[112:115]
    ds_read_b128 v[88:91], v17 offset:1728
    v_mfma_f32_16x16x32_bf16 v[116:119], v[48:51], v[84:87], v[116:119]
    v_mfma_f32_16x16x32_bf16 v[120:123], v[48:51], v[76:79], v[120:123]
    ds_read_b128 v[48:51], v16 offset:3264
    v_mfma_f32_16x16x32_bf16 v[108:111], v[56:59], v[84:87], v[108:111]
    v_mfma_f32_16x16x32_bf16 v[112:115], v[52:55], v[84:87], v[112:115]
    ds_read_b128 v[84:87], v17 offset:1216
    v_mfma_f32_16x16x32_bf16 v[116:119], v[52:55], v[80:83], v[116:119]
    ds_read_b128 v[52:55], v16 offset:2752
    s_waitcnt lgkmcnt(7)
    v_mfma_f32_16x16x32_bf16 v[108:111], v[60:63], v[80:83], v[108:111]
    v_mfma_f32_16x16x32_bf16 v[112:115], v[56:59], v[80:83], v[112:115]
    ds_read_b128 v[80:83], v17 offset:704
    v_mfma_f32_16x16x32_bf16 v[116:119], v[56:59], v[76:79], v[116:119]
    ds_read_b128 v[56:59], v16 offset:2240
    v_mfma_f32_16x16x32_bf16 v[108:111], v[64:67], v[76:79], v[108:111]
    ds_read_b128 v[64:67], v16 offset:1216
    v_mfma_f32_16x16x32_bf16 v[112:115], v[60:63], v[76:79], v[112:115]
    ds_read_b128 v[76:79], v17 offset:192
    s_waitcnt lgkmcnt(6)
    v_mfma_f32_16x16x32_bf16 v[108:111], v[44:47], v[96:99], v[108:111]
    ds_read_b128 v[60:63], v16 offset:1728
    v_mfma_f32_16x16x32_bf16 v[108:111], v[48:51], v[92:95], v[108:111]
    ds_read_b128 v[96:99], v17 offset:2688
    v_mfma_f32_16x16x32_bf16 v[112:115], v[44:47], v[92:95], v[112:115]
    ds_read_b128 v[92:95], v17 offset:2176
    v_mfma_f32_16x16x32_bf16 v[116:119], v[44:47], v[88:91], v[116:119]
    s_waitcnt lgkmcnt(3)
    v_mfma_f32_16x16x32_bf16 v[120:123], v[44:47], v[80:83], v[120:123]
    v_mfma_f32_16x16x32_bf16 v[124:127], v[44:47], v[76:79], v[124:127]
    ds_read_b128 v[44:47], v16 offset:3712
    v_mfma_f32_16x16x32_bf16 v[108:111], v[52:55], v[88:91], v[108:111]
    v_mfma_f32_16x16x32_bf16 v[112:115], v[48:51], v[88:91], v[112:115]
    ds_read_b128 v[88:91], v17 offset:1664
    v_mfma_f32_16x16x32_bf16 v[116:119], v[48:51], v[84:87], v[116:119]
    v_mfma_f32_16x16x32_bf16 v[120:123], v[48:51], v[76:79], v[120:123]
    ds_read_b128 v[48:51], v16 offset:3200
    v_mfma_f32_16x16x32_bf16 v[108:111], v[56:59], v[84:87], v[108:111]
    v_mfma_f32_16x16x32_bf16 v[112:115], v[52:55], v[84:87], v[112:115]
    ds_read_b128 v[84:87], v17 offset:1152
    v_mfma_f32_16x16x32_bf16 v[116:119], v[52:55], v[80:83], v[116:119]
    ds_read_b128 v[52:55], v16 offset:2688
    s_waitcnt lgkmcnt(7)
    v_mfma_f32_16x16x32_bf16 v[108:111], v[60:63], v[80:83], v[108:111]
    v_mfma_f32_16x16x32_bf16 v[112:115], v[56:59], v[80:83], v[112:115]
    ds_read_b128 v[80:83], v17 offset:640
    v_mfma_f32_16x16x32_bf16 v[116:119], v[56:59], v[76:79], v[116:119]
    ds_read_b128 v[56:59], v16 offset:2176
    v_mfma_f32_16x16x32_bf16 v[108:111], v[64:67], v[76:79], v[108:111]
    ds_read_b128 v[64:67], v16 offset:1152
    v_mfma_f32_16x16x32_bf16 v[112:115], v[60:63], v[76:79], v[112:115]
    ds_read_b128 v[76:79], v17 offset:128
    s_waitcnt lgkmcnt(6)
    v_mfma_f32_16x16x32_bf16 v[108:111], v[44:47], v[96:99], v[108:111]
    ds_read_b128 v[60:63], v16 offset:1664
    v_mfma_f32_16x16x32_bf16 v[108:111], v[48:51], v[92:95], v[108:111]
    ds_read_b128 v[96:99], v17 offset:2624
    v_mfma_f32_16x16x32_bf16 v[112:115], v[44:47], v[92:95], v[112:115]
    ds_read_b128 v[92:95], v17 offset:2112
    v_mfma_f32_16x16x32_bf16 v[116:119], v[44:47], v[88:91], v[116:119]
    s_waitcnt lgkmcnt(3)
    v_mfma_f32_16x16x32_bf16 v[120:123], v[44:47], v[80:83], v[120:123]
    v_mfma_f32_16x16x32_bf16 v[124:127], v[44:47], v[76:79], v[124:127]
    ds_read_b128 v[44:47], v16 offset:3648
    v_mfma_f32_16x16x32_bf16 v[108:111], v[52:55], v[88:91], v[108:111]
    v_mfma_f32_16x16x32_bf16 v[112:115], v[48:51], v[88:91], v[112:115]
    ds_read_b128 v[88:91], v17 offset:1600
    v_mfma_f32_16x16x32_bf16 v[116:119], v[48:51], v[84:87], v[116:119]
    v_mfma_f32_16x16x32_bf16 v[120:123], v[48:51], v[76:79], v[120:123]
    ds_read_b128 v[48:51], v16 offset:3136
    v_mfma_f32_16x16x32_bf16 v[108:111], v[56:59], v[84:87], v[108:111]
    v_mfma_f32_16x16x32_bf16 v[112:115], v[52:55], v[84:87], v[112:115]
    ds_read_b128 v[84:87], v17 offset:1088
    v_mfma_f32_16x16x32_bf16 v[116:119], v[52:55], v[80:83], v[116:119]
    ds_read_b128 v[52:55], v16 offset:2624
    s_waitcnt lgkmcnt(7)
    v_mfma_f32_16x16x32_bf16 v[108:111], v[60:63], v[80:83], v[108:111]
    v_mfma_f32_16x16x32_bf16 v[112:115], v[56:59], v[80:83], v[112:115]
    ds_read_b128 v[80:83], v17 offset:576
    v_mfma_f32_16x16x32_bf16 v[116:119], v[56:59], v[76:79], v[116:119]
    ds_read_b128 v[56:59], v16 offset:2112
    v_mfma_f32_16x16x32_bf16 v[108:111], v[64:67], v[76:79], v[108:111]
    ds_read_b128 v[64:67], v16 offset:1088
    v_mfma_f32_16x16x32_bf16 v[112:115], v[60:63], v[76:79], v[112:115]
    ds_read_b128 v[76:79], v17 offset:64
    s_waitcnt lgkmcnt(6)
    v_mfma_f32_16x16x32_bf16 v[108:111], v[44:47], v[96:99], v[108:111]
    ds_read_b128 v[60:63], v16 offset:1600
    v_mfma_f32_16x16x32_bf16 v[108:111], v[48:51], v[92:95], v[108:111]
    ds_read_b128 v[96:99], v17 offset:2560
    v_mfma_f32_16x16x32_bf16 v[112:115], v[44:47], v[92:95], v[112:115]
    ds_read_b128 v[92:95], v17 offset:2048
    v_mfma_f32_16x16x32_bf16 v[116:119], v[44:47], v[88:91], v[116:119]
    s_waitcnt lgkmcnt(3)
    v_mfma_f32_16x16x32_bf16 v[120:123], v[44:47], v[80:83], v[120:123]
    v_mfma_f32_16x16x32_bf16 v[124:127], v[44:47], v[76:79], v[124:127]
    ds_read_b128 v[44:47], v16 offset:3584
    v_mfma_f32_16x16x32_bf16 v[108:111], v[52:55], v[88:91], v[108:111]
    v_mfma_f32_16x16x32_bf16 v[112:115], v[48:51], v[88:91], v[112:115]
    ds_read_b128 v[88:91], v17 offset:1536
    v_mfma_f32_16x16x32_bf16 v[116:119], v[48:51], v[84:87], v[116:119]
    v_mfma_f32_16x16x32_bf16 v[120:123], v[48:51], v[76:79], v[120:123]
    ds_read_b128 v[48:51], v16 offset:3072
    v_mfma_f32_16x16x32_bf16 v[108:111], v[56:59], v[84:87], v[108:111]
    v_mfma_f32_16x16x32_bf16 v[112:115], v[52:55], v[84:87], v[112:115]
    ds_read_b128 v[84:87], v17 offset:1024
    v_mfma_f32_16x16x32_bf16 v[116:119], v[52:55], v[80:83], v[116:119]
    ds_read_b128 v[52:55], v16 offset:2560
    s_waitcnt lgkmcnt(7)
    v_mfma_f32_16x16x32_bf16 v[108:111], v[60:63], v[80:83], v[108:111]
    v_mfma_f32_16x16x32_bf16 v[112:115], v[56:59], v[80:83], v[112:115]
    ds_read_b128 v[80:83], v17 offset:512
    v_mfma_f32_16x16x32_bf16 v[116:119], v[56:59], v[76:79], v[116:119]
    ds_read_b128 v[56:59], v16 offset:2048
    v_mfma_f32_16x16x32_bf16 v[108:111], v[64:67], v[76:79], v[108:111]
    ds_read_b128 v[64:67], v16 offset:1024
    v_mfma_f32_16x16x32_bf16 v[112:115], v[60:63], v[76:79], v[112:115]
    ds_read_b128 v[76:79], v17 offset:0
    s_waitcnt lgkmcnt(6)
    v_mfma_f32_16x16x32_bf16 v[108:111], v[44:47], v[96:99], v[108:111]
    ds_read_b128 v[60:63], v16 offset:1536
    v_mfma_f32_16x16x32_bf16 v[108:111], v[48:51], v[92:95], v[108:111]
    v_mfma_f32_16x16x32_bf16 v[112:115], v[44:47], v[92:95], v[112:115]
    v_mfma_f32_16x16x32_bf16 v[116:119], v[44:47], v[88:91], v[116:119]
    s_waitcnt lgkmcnt(1)
    v_mfma_f32_16x16x32_bf16 v[120:123], v[44:47], v[80:83], v[120:123]
    v_mfma_f32_16x16x32_bf16 v[124:127], v[44:47], v[76:79], v[124:127]
    v_mfma_f32_16x16x32_bf16 v[108:111], v[52:55], v[88:91], v[108:111]
    v_mfma_f32_16x16x32_bf16 v[112:115], v[48:51], v[88:91], v[112:115]
    v_mfma_f32_16x16x32_bf16 v[116:119], v[48:51], v[84:87], v[116:119]
    v_mfma_f32_16x16x32_bf16 v[120:123], v[48:51], v[76:79], v[120:123]
    v_mfma_f32_16x16x32_bf16 v[108:111], v[56:59], v[84:87], v[108:111]
    v_mfma_f32_16x16x32_bf16 v[112:115], v[52:55], v[84:87], v[112:115]
    v_mfma_f32_16x16x32_bf16 v[116:119], v[52:55], v[80:83], v[116:119]
    s_waitcnt lgkmcnt(0)
    v_mfma_f32_16x16x32_bf16 v[108:111], v[60:63], v[80:83], v[108:111]
    v_mfma_f32_16x16x32_bf16 v[112:115], v[56:59], v[80:83], v[112:115]
    v_mfma_f32_16x16x32_bf16 v[116:119], v[56:59], v[76:79], v[116:119]
    v_mfma_f32_16x16x32_bf16 v[108:111], v[64:67], v[76:79], v[108:111]
    v_mfma_f32_16x16x32_bf16 v[112:115], v[60:63], v[76:79], v[112:115]
    v_cvt_pk_bf16_f32 v136, v124, v125
    v_cvt_pk_bf16_f32 v137, v126, v127
    ds_write_b64 v19, v[136:137] offset:0
    v_cvt_pk_bf16_f32 v134, v120, v121
    v_cvt_pk_bf16_f32 v135, v122, v123
    ds_write_b64 v19, v[134:135] offset:512
    v_cvt_pk_bf16_f32 v132, v116, v117
    v_cvt_pk_bf16_f32 v133, v118, v119
    ds_write_b64 v19, v[132:133] offset:1536
    v_cvt_pk_bf16_f32 v128, v108, v109
    v_cvt_pk_bf16_f32 v129, v110, v111
    ds_write_b64 v19, v[128:129] offset:2560
    v_cvt_pk_bf16_f32 v130, v112, v113
    v_cvt_pk_bf16_f32 v131, v114, v115
    ds_write_b64 v19, v[130:131] offset:2048
L_convdone:
    s_waitcnt lgkmcnt(0)
    v_mov_b32 v20, 86352
    v_mov_b32 v21, 1
    s_mov_b64 exec, 1
    ds_add_rtn_u32 v22, v20, v21
    s_waitcnt lgkmcnt(0)
    v_readfirstlane_b32 s39, v22
    s_mov_b64 exec, -1
    s_cmp_eq_u32 s39, 3
    s_cbranch_scc1 L_clast
    v_mov_b32 v20, 86352
    s_mov_b32 s41, 0
L_ccnt_lw:
    ds_read_b32 v21, v20
    s_add_u32 s41, s41, 1
    s_cmp_gt_u32 s41, 1000000
    s_cbranch_scc1 L_ccnt_lwd
    s_waitcnt lgkmcnt(0)
    v_cmp_gt_u32 vcc, 4, v21
    s_nop 0
    s_cbranch_vccz L_ccnt_lwd
    s_branch L_ccnt_lw
L_ccnt_lwd:
    s_waitcnt lgkmcnt(0)
L_clast:
    ds_read_b64 v[140:141], v9 offset:0
    ds_read_b64 v[144:145], v9 offset:1024
    ds_read_b64 v[148:149], v9 offset:2048
    ds_read_b64 v[152:153], v9 offset:3072
    s_waitcnt lgkmcnt(3)
    global_store_dwordx4 v10, v[140:143], s[44:45] sc1
    s_waitcnt lgkmcnt(2)
    global_store_dwordx4 v10, v[144:147], s[46:47] sc1
    s_waitcnt lgkmcnt(1)
    global_store_dwordx4 v10, v[148:151], s[48:49] sc1
    s_waitcnt lgkmcnt(0)
    global_store_dwordx4 v10, v[152:155], s[50:51] sc1
    s_branch L_fin
L_tmain:
    s_mov_b32 s60, 0x3fb8aa00
    s_mov_b32 s61, 0x36eca570
    s_mov_b32 s62, 0xffff0000
    s_mov_b32 s63, 0x80000000
    s_mul_i32 s41, s36, 34816
    s_lshl_b32 s43, s37, 8
    s_add_u32 s41, s41, s43
    s_mov_b32 m0, s41
    v_lshlrev_b32 v3, 4, v2
    s_mul_i32 s39, s3, 16384
    s_add_u32 s39, s39, 0x100000
    s_add_u32 s52, s30, s39
    s_addc_u32 s53, s31, 0
    s_add_u32 s58, s52, 8192
    s_addc_u32 s59, s53, 0
    s_mul_i32 s39, s2, 16384
    s_add_u32 s39, s39, 0x580000
    s_add_u32 s54, s30, s39
    s_addc_u32 s55, s31, 0
    s_add_u32 s56, s54, 8192
    s_addc_u32 s57, s55, 0
    v_and_b32 v17, 2, v2
    v_mul_u32_u24 v17, 4640, v17
    v_lshrrev_b32 v20, 2, v2
    v_lshl_add_u32 v17, v20, 4, v17
    v_and_b32 v21, 1, v2
    v_lshl_add_u32 v4, v21, 3, v17
    v_add_u32 v4, 91472, v4
    v_mul_u32_u24 v5, 4160, v21
    s_mov_b32 s38, 69632
    v_add3_u32 v5, v5, v19, s38
    v_bfe_u32 v22, v2, 1, 1
    v_lshlrev_b32 v6, 2, v21
    v_lshl_add_u32 v6, v22, 1, v6
    s_lshl_b32 s39, s2, 3
    v_add_u32 v6, s39, v6
    v_lshlrev_b32 v7, 10, v6
    v_lshl_add_u32 v7, v20, 2, v7
    v_cmp_eq_u32 s[66:67], 1, v22
    v_lshlrev_b32 v53, 3, v2
    v_sub_u32 v53, 0x7ff, v53
    s_mov_b32 s42, 88672
    s_movk_i32 s39, 0x80
    s_mov_b32 s41, 0xffffbd00
    v_subrev_u32 v54, 0, v53
    v_subrev_u32 v55, 1, v53
    v_max_i32 v56, s39, v54
    v_max_i32 v57, s39, v55
    v_cvt_f32_i32 v56, v56
    v_cvt_f32_i32 v57, v57
    v_min_i32 v54, s39, v54
    v_min_i32 v55, s39, v55
    v_cvt_pk_bf16_f32 v56, v56, v57
    v_and_b32 v57, 0xffff, v56
    v_add3_u32 v54, v54, v57, s41
    v_lshl_add_u32 v32, v54, 1, s42
    v_lshrrev_b32 v56, 16, v56
    v_add3_u32 v55, v55, v56, s41
    v_lshl_add_u32 v33, v55, 1, s42
    v_subrev_u32 v54, 2, v53
    v_subrev_u32 v55, 3, v53
    v_max_i32 v56, s39, v54
    v_max_i32 v57, s39, v55
    v_cvt_f32_i32 v56, v56
    v_cvt_f32_i32 v57, v57
    v_min_i32 v54, s39, v54
    v_min_i32 v55, s39, v55
    v_cvt_pk_bf16_f32 v56, v56, v57
    v_and_b32 v57, 0xffff, v56
    v_add3_u32 v54, v54, v57, s41
    v_lshl_add_u32 v34, v54, 1, s42
    v_lshrrev_b32 v56, 16, v56
    v_add3_u32 v55, v55, v56, s41
    v_lshl_add_u32 v35, v55, 1, s42
    v_subrev_u32 v54, 4, v53
    v_subrev_u32 v55, 5, v53
    v_max_i32 v56, s39, v54
    v_max_i32 v57, s39, v55
    v_cvt_f32_i32 v56, v56
    v_cvt_f32_i32 v57, v57
    v_min_i32 v54, s39, v54
    v_min_i32 v55, s39, v55
    v_cvt_pk_bf16_f32 v56, v56, v57
    v_and_b32 v57, 0xffff, v56
    v_add3_u32 v54, v54, v57, s41
    v_lshl_add_u32 v36, v54, 1, s42
    v_lshrrev_b32 v56, 16, v56
    v_add3_u32 v55, v55, v56, s41
    v_lshl_add_u32 v37, v55, 1, s42
    v_subrev_u32 v54, 6, v53
    v_subrev_u32 v55, 7, v53
    v_max_i32 v56, s39, v54
    v_max_i32 v57, s39, v55
    v_cvt_f32_i32 v56, v56
    v_cvt_f32_i32 v57, v57
    v_min_i32 v54, s39, v54
    v_min_i32 v55, s39, v55
    v_cvt_pk_bf16_f32 v56, v56, v57
    v_and_b32 v57, 0xffff, v56
    v_add3_u32 v54, v54, v57, s41
    v_lshl_add_u32 v38, v54, 1, s42
    v_lshrrev_b32 v56, 16, v56
    v_add3_u32 v55, v55, v56, s41
    v_lshl_add_u32 v39, v55, 1, s42
    v_subrev_u32 v54, 8, v53
    v_subrev_u32 v55, 9, v53
    v_max_i32 v56, s39, v54
    v_max_i32 v57, s39, v55
    v_cvt_f32_i32 v56, v56
    v_cvt_f32_i32 v57, v57
    v_min_i32 v54, s39, v54
    v_min_i32 v55, s39, v55
    v_cvt_pk_bf16_f32 v56, v56, v57
    v_and_b32 v57, 0xffff, v56
    v_add3_u32 v54, v54, v57, s41
    v_lshl_add_u32 v40, v54, 1, s42
    v_lshrrev_b32 v56, 16, v56
    v_add3_u32 v55, v55, v56, s41
    v_lshl_add_u32 v41, v55, 1, s42
    v_subrev_u32 v54, 10, v53
    v_subrev_u32 v55, 11, v53
    v_max_i32 v56, s39, v54
    v_max_i32 v57, s39, v55
    v_cvt_f32_i32 v56, v56
    v_cvt_f32_i32 v57, v57
    v_min_i32 v54, s39, v54
    v_min_i32 v55, s39, v55
    v_cvt_pk_bf16_f32 v56, v56, v57
    v_and_b32 v57, 0xffff, v56
    v_add3_u32 v54, v54, v57, s41
    v_lshl_add_u32 v42, v54, 1, s42
    v_lshlrev_b32 v43, 4, v2
    v_add_u32 v43, 0, v43
    s_waitcnt vmcnt(4) lgkmcnt(0)
    s_add_u32 s33, s33, 0x9e3779b9
    s_cmp_eq_u32 s36, 0
    s_cselect_b32 s39, 16, 0
    s_lshl_b32 s40, s40, s39
    s_and_b32 s40, s40, s62
    v_mov_b32 v52, s40
    v_lshlrev_b32 v28, 16, v28
    v_lshlrev_b32 v29, 16, v29
    v_mul_f32 v54, s60, v52
    v_rndne_f32 v55, v54
    v_sub_f32 v54, v54, v55
    v_fmac_f32 v54, s61, v52
    v_exp_f32 v53, v54
    v_cvt_i32_f32 v55, v55
    v_ldexp_f32 v53, v53, v55
    v_mul_f32 v57, s60, v28
    v_rndne_f32 v58, v57
    v_sub_f32 v57, v57, v58
    v_fmac_f32 v57, s61, v28
    v_exp_f32 v56, v57
    v_cvt_i32_f32 v58, v58
    v_ldexp_f32 v56, v56, v58
    v_cvt_pk_bf16_f32 v53, v53, v56
    v_and_b32 v56, s62, v53
    v_lshlrev_b32 v53, 16, v53
    v_mul_f32 v56, v56, v53
    v_mul_f32 v57, v29, v53
    v_mul_f32 v56, 0xbfb8aa3b, v56
    v_mul_f32 v57, 0x3e22f983, v57
    v_mul_f32 v44, 0x3f800000, v56
    v_mul_f32 v45, 0x3f800000, v57
    v_exp_f32 v44, v44
    v_fract_f32 v45, v45
    v_cos_f32 v46, v45
    v_sin_f32 v47, v45
    v_mul_f32 v64, v44, v46
    v_mul_f32 v65, v44, v47
    v_mul_f32 v44, 0x43800000, v56
    v_mul_f32 v45, 0x43800000, v57
    v_exp_f32 v44, v44
    v_fract_f32 v45, v45
    v_cos_f32 v46, v45
    v_sin_f32 v47, v45
    v_mul_f32 v66, v44, v46
    v_mul_f32 v67, v44, v47
    v_lshlrev_b32 v30, 16, v30
    v_lshlrev_b32 v31, 16, v31
    v_add_f32 v53, v53, v53
    v_mul_f32 v68, v30, v53
    v_mul_f32 v69, v31, v53
    s_mul_i32 s39, s35, 1536
    s_add_u32 s39, s39, 135632
    v_lshl_add_u32 v16, v1, 2, s39
    ds_write_b32 v16, v64 offset:0
    ds_write_b32 v16, v65 offset:256
    ds_write_b32 v16, v66 offset:512
    ds_write_b32 v16, v67 offset:768
    ds_write_b32 v16, v68 offset:1024
    ds_write_b32 v16, v69 offset:1280
    v_mul_f32 v44, 0x41000000, v56
    v_mul_f32 v45, 0x41000000, v57
    v_exp_f32 v44, v44
    v_fract_f32 v45, v45
    v_cos_f32 v46, v45
    v_sin_f32 v47, v45
    v_mul_f32 v60, v44, v46
    v_mul_f32 v61, v44, v47
    v_mul_f32 v44, 0x42800000, v56
    v_mul_f32 v45, 0x42800000, v57
    v_exp_f32 v44, v44
    v_fract_f32 v45, v45
    v_cos_f32 v46, v45
    v_sin_f32 v47, v45
    v_mul_f32 v62, v44, v46
    v_mul_f32 v63, v44, v47
    s_waitcnt lgkmcnt(0)
    s_barrier
    v_mov_b32 v58, 0x3f80
    ds_write_addtid_b32 v58 offset:0
    v_cvt_pk_bf16_f32 v98, v60, v61
    v_pk_mul_f32 v[64:65], v[62:63], v[62:63] op_sel_hi:[1,0]
    v_pk_fma_f32 v[64:65], v[62:63], v[62:63], v[64:65] op_sel:[1,1,0] op_sel_hi:[0,1,1] neg_lo:[1,0,0]
    v_pk_mul_f32 v[66:67], v[64:65], v[62:63] op_sel_hi:[1,0]
    v_pk_fma_f32 v[66:67], v[64:65], v[62:63], v[66:67] op_sel:[1,1,0] op_sel_hi:[0,1,1] neg_lo:[1,0,0]
    v_pk_mul_f32 v[68:69], v[60:61], v[60:61] op_sel_hi:[1,0]
    v_pk_fma_f32 v[68:69], v[60:61], v[60:61], v[68:69] op_sel:[1,1,0] op_sel_hi:[0,1,1] neg_lo:[1,0,0]
    ds_write_addtid_b32 v98 offset:544
    v_cvt_pk_bf16_f32 v99, v68, v69
    v_pk_mul_f32 v[70:71], v[68:69], v[60:61] op_sel_hi:[1,0]
    v_pk_fma_f32 v[70:71], v[68:69], v[60:61], v[70:71] op_sel:[1,1,0] op_sel_hi:[0,1,1] neg_lo:[1,0,0]
    ds_write_addtid_b32 v99 offset:1088
    v_cvt_pk_bf16_f32 v96, v70, v71
    v_pk_mul_f32 v[72:73], v[70:71], v[60:61] op_sel_hi:[1,0]
    v_pk_fma_f32 v[72:73], v[70:71], v[60:61], v[72:73] op_sel:[1,1,0] op_sel_hi:[0,1,1] neg_lo:[1,0,0]
    ds_write_addtid_b32 v96 offset:1632
    v_cvt_pk_bf16_f32 v97, v72, v73
    v_pk_mul_f32 v[74:75], v[72:73], v[60:61] op_sel_hi:[1,0]
    v_pk_fma_f32 v[74:75], v[72:73], v[60:61], v[74:75] op_sel:[1,1,0] op_sel_hi:[0,1,1] neg_lo:[1,0,0]
    ds_write_addtid_b32 v97 offset:2176
    v_cvt_pk_bf16_f32 v98, v74, v75
    v_pk_mul_f32 v[76:77], v[74:75], v[60:61] op_sel_hi:[1,0]
    v_pk_fma_f32 v[76:77], v[74:75], v[60:61], v[76:77] op_sel:[1,1,0] op_sel_hi:[0,1,1] neg_lo:[1,0,0]
    ds_write_addtid_b32 v98 offset:2720
    v_cvt_pk_bf16_f32 v99, v76, v77
    v_pk_mul_f32 v[78:79], v[76:77], v[60:61] op_sel_hi:[1,0]
    v_pk_fma_f32 v[78:79], v[76:77], v[60:61], v[78:79] op_sel:[1,1,0] op_sel_hi:[0,1,1] neg_lo:[1,0,0]
    ds_write_addtid_b32 v99 offset:3264
    v_cvt_pk_bf16_f32 v96, v78, v79
    ds_write_addtid_b32 v96 offset:3808
    v_cvt_pk_bf16_f32 v97, v62, v63
    v_pk_mul_f32 v[46:47], v[60:61], v[62:63] op_sel_hi:[1,0]
    v_pk_fma_f32 v[46:47], v[60:61], v[62:63], v[46:47] op_sel:[1,1,0] op_sel_hi:[0,1,1] neg_lo:[1,0,0]
    ds_write_addtid_b32 v97 offset:4352
    v_cvt_pk_bf16_f32 v98, v46, v47
    v_pk_mul_f32 v[48:49], v[68:69], v[62:63] op_sel_hi:[1,0]
    v_pk_fma_f32 v[48:49], v[68:69], v[62:63], v[48:49] op_sel:[1,1,0] op_sel_hi:[0,1,1] neg_lo:[1,0,0]
    ds_write_addtid_b32 v98 offset:4896
    v_cvt_pk_bf16_f32 v99, v48, v49
    v_pk_mul_f32 v[50:51], v[70:71], v[62:63] op_sel_hi:[1,0]
    v_pk_fma_f32 v[50:51], v[70:71], v[62:63], v[50:51] op_sel:[1,1,0] op_sel_hi:[0,1,1] neg_lo:[1,0,0]
    ds_write_addtid_b32 v99 offset:5440
    v_cvt_pk_bf16_f32 v96, v50, v51
    v_pk_mul_f32 v[44:45], v[72:73], v[62:63] op_sel_hi:[1,0]
    v_pk_fma_f32 v[44:45], v[72:73], v[62:63], v[44:45] op_sel:[1,1,0] op_sel_hi:[0,1,1] neg_lo:[1,0,0]
    ds_write_addtid_b32 v96 offset:5984
    v_cvt_pk_bf16_f32 v97, v44, v45
    v_pk_mul_f32 v[46:47], v[74:75], v[62:63] op_sel_hi:[1,0]
    v_pk_fma_f32 v[46:47], v[74:75], v[62:63], v[46:47] op_sel:[1,1,0] op_sel_hi:[0,1,1] neg_lo:[1,0,0]
    ds_write_addtid_b32 v97 offset:6528
    v_cvt_pk_bf16_f32 v98, v46, v47
    v_pk_mul_f32 v[48:49], v[76:77], v[62:63] op_sel_hi:[1,0]
    v_pk_fma_f32 v[48:49], v[76:77], v[62:63], v[48:49] op_sel:[1,1,0] op_sel_hi:[0,1,1] neg_lo:[1,0,0]
    ds_write_addtid_b32 v98 offset:7072
    v_cvt_pk_bf16_f32 v99, v48, v49
    v_pk_mul_f32 v[50:51], v[78:79], v[62:63] op_sel_hi:[1,0]
    v_pk_fma_f32 v[50:51], v[78:79], v[62:63], v[50:51] op_sel:[1,1,0] op_sel_hi:[0,1,1] neg_lo:[1,0,0]
    ds_write_addtid_b32 v99 offset:7616
    v_cvt_pk_bf16_f32 v96, v50, v51
    ds_write_addtid_b32 v96 offset:8160
    v_cvt_pk_bf16_f32 v97, v64, v65
    v_pk_mul_f32 v[46:47], v[60:61], v[64:65] op_sel_hi:[1,0]
    v_pk_fma_f32 v[46:47], v[60:61], v[64:65], v[46:47] op_sel:[1,1,0] op_sel_hi:[0,1,1] neg_lo:[1,0,0]
    ds_write_addtid_b32 v97 offset:8704
    v_cvt_pk_bf16_f32 v98, v46, v47
    v_pk_mul_f32 v[48:49], v[68:69], v[64:65] op_sel_hi:[1,0]
    v_pk_fma_f32 v[48:49], v[68:69], v[64:65], v[48:49] op_sel:[1,1,0] op_sel_hi:[0,1,1] neg_lo:[1,0,0]
    ds_write_addtid_b32 v98 offset:9248
    v_cvt_pk_bf16_f32 v99, v48, v49
    v_pk_mul_f32 v[50:51], v[70:71], v[64:65] op_sel_hi:[1,0]
    v_pk_fma_f32 v[50:51], v[70:71], v[64:65], v[50:51] op_sel:[1,1,0] op_sel_hi:[0,1,1] neg_lo:[1,0,0]
    ds_write_addtid_b32 v99 offset:9792
    v_cvt_pk_bf16_f32 v96, v50, v51
    v_pk_mul_f32 v[44:45], v[72:73], v[64:65] op_sel_hi:[1,0]
    v_pk_fma_f32 v[44:45], v[72:73], v[64:65], v[44:45] op_sel:[1,1,0] op_sel_hi:[0,1,1] neg_lo:[1,0,0]
    ds_write_addtid_b32 v96 offset:10336
    v_cvt_pk_bf16_f32 v97, v44, v45
    v_pk_mul_f32 v[46:47], v[74:75], v[64:65] op_sel_hi:[1,0]
    v_pk_fma_f32 v[46:47], v[74:75], v[64:65], v[46:47] op_sel:[1,1,0] op_sel_hi:[0,1,1] neg_lo:[1,0,0]
    ds_write_addtid_b32 v97 offset:10880
    v_cvt_pk_bf16_f32 v98, v46, v47
    v_pk_mul_f32 v[48:49], v[76:77], v[64:65] op_sel_hi:[1,0]
    v_pk_fma_f32 v[48:49], v[76:77], v[64:65], v[48:49] op_sel:[1,1,0] op_sel_hi:[0,1,1] neg_lo:[1,0,0]
    ds_write_addtid_b32 v98 offset:11424
    v_cvt_pk_bf16_f32 v99, v48, v49
    v_pk_mul_f32 v[50:51], v[78:79], v[64:65] op_sel_hi:[1,0]
    v_pk_fma_f32 v[50:51], v[78:79], v[64:65], v[50:51] op_sel:[1,1,0] op_sel_hi:[0,1,1] neg_lo:[1,0,0]
    ds_write_addtid_b32 v99 offset:11968
    v_cvt_pk_bf16_f32 v96, v50, v51
    ds_write_addtid_b32 v96 offset:12512
    v_cvt_pk_bf16_f32 v97, v66, v67
    v_pk_mul_f32 v[46:47], v[60:61], v[66:67] op_sel_hi:[1,0]
    v_pk_fma_f32 v[46:47], v[60:61], v[66:67], v[46:47] op_sel:[1,1,0] op_sel_hi:[0,1,1] neg_lo:[1,0,0]
    ds_write_addtid_b32 v97 offset:13056
    v_cvt_pk_bf16_f32 v98, v46, v47
    v_pk_mul_f32 v[48:49], v[68:69], v[66:67] op_sel_hi:[1,0]
    v_pk_fma_f32 v[48:49], v[68:69], v[66:67], v[48:49] op_sel:[1,1,0] op_sel_hi:[0,1,1] neg_lo:[1,0,0]
    ds_write_addtid_b32 v98 offset:13600
    v_cvt_pk_bf16_f32 v99, v48, v49
    v_pk_mul_f32 v[50:51], v[70:71], v[66:67] op_sel_hi:[1,0]
    v_pk_fma_f32 v[50:51], v[70:71], v[66:67], v[50:51] op_sel:[1,1,0] op_sel_hi:[0,1,1] neg_lo:[1,0,0]
    ds_write_addtid_b32 v99 offset:14144
    v_cvt_pk_bf16_f32 v96, v50, v51
    v_pk_mul_f32 v[44:45], v[72:73], v[66:67] op_sel_hi:[1,0]
    v_pk_fma_f32 v[44:45], v[72:73], v[66:67], v[44:45] op_sel:[1,1,0] op_sel_hi:[0,1,1] neg_lo:[1,0,0]
    ds_write_addtid_b32 v96 offset:14688
    v_cvt_pk_bf16_f32 v97, v44, v45
    v_pk_mul_f32 v[46:47], v[74:75], v[66:67] op_sel_hi:[1,0]
    v_pk_fma_f32 v[46:47], v[74:75], v[66:67], v[46:47] op_sel:[1,1,0] op_sel_hi:[0,1,1] neg_lo:[1,0,0]
    ds_write_addtid_b32 v97 offset:15232
    v_cvt_pk_bf16_f32 v98, v46, v47
    v_pk_mul_f32 v[48:49], v[76:77], v[66:67] op_sel_hi:[1,0]
    v_pk_fma_f32 v[48:49], v[76:77], v[66:67], v[48:49] op_sel:[1,1,0] op_sel_hi:[0,1,1] neg_lo:[1,0,0]
    ds_write_addtid_b32 v98 offset:15776
    v_cvt_pk_bf16_f32 v99, v48, v49
    v_pk_mul_f32 v[50:51], v[78:79], v[66:67] op_sel_hi:[1,0]
    v_pk_fma_f32 v[50:51], v[78:79], v[66:67], v[50:51] op_sel:[1,1,0] op_sel_hi:[0,1,1] neg_lo:[1,0,0]
    ds_write_addtid_b32 v99 offset:16320
    v_cvt_pk_bf16_f32 v96, v50, v51
    ds_write_addtid_b32 v96 offset:16864
    s_waitcnt lgkmcnt(0)
    s_barrier
    v_mov_b32 v16, 86392
    s_mov_b32 s41, 0
L_hint_lw:
    ds_read_b32 v17, v16
    s_add_u32 s41, s41, 1
    s_cmp_gt_u32 s41, 1000000
    s_cbranch_scc1 L_hint_lwd
    s_waitcnt lgkmcnt(0)
    v_cmp_gt_u32 vcc, 1, v17
    s_nop 0
    s_cbranch_vccz L_hint_lwd
    s_sleep 1
    s_branch L_hint_lw
L_hint_lwd:
    s_waitcnt lgkmcnt(0)
    v_add_u32 v8, 4096, v3
    global_load_dwordx4 v[44:47], v3, s[52:53] sc1
    global_load_dwordx4 v[48:51], v8, s[52:53] sc1
    global_load_dwordx4 v[52:55], v3, s[58:59] sc1
    global_load_dwordx4 v[56:59], v8, s[58:59] sc1
    v_mov_b32 v116, 86360
    v_mov_b32 v117, 1
    s_mov_b64 exec, 1
    ds_add_u32 v116, v117
    s_mov_b64 exec, -1
    v_mov_b32 v116, 86388
    s_mov_b32 s41, 0
L_ktt_lw:
    ds_read_b32 v117, v116
    s_add_u32 s41, s41, 1
    s_cmp_gt_u32 s41, 1000000
    s_cbranch_scc1 L_ktt_lwd
    s_waitcnt lgkmcnt(0)
    v_cmp_gt_u32 vcc, 4, v117
    s_nop 0
    s_cbranch_vccz L_ktt_lwd
    s_branch L_ktt_lw
L_ktt_lwd:
    s_waitcnt lgkmcnt(0)
    ds_read_u16 v64, v32 offset:0
    ds_read_u16 v65, v33 offset:0
    ds_read_u16 v66, v34 offset:0
    ds_read_u16 v67, v35 offset:0
    ds_read_u16 v68, v36 offset:0
    ds_read_u16 v69, v37 offset:0
    ds_read_u16 v70, v38 offset:0
    ds_read_u16 v71, v39 offset:0
    ds_read_u16 v72, v40 offset:0
    ds_read_u16 v73, v41 offset:0
    ds_read_u16 v74, v42 offset:0
    ds_read_u16 v76, v32 offset:1408
    ds_read_u16 v77, v33 offset:1408
    ds_read_u16 v78, v34 offset:1408
    ds_read_u16 v79, v35 offset:1408
    ds_read_u16 v80, v36 offset:1408
    ds_read_u16 v81, v37 offset:1408
    ds_read_u16 v82, v38 offset:1408
    ds_read_u16 v83, v39 offset:1408
    ds_read_u16 v84, v40 offset:1408
    ds_read_u16 v85, v41 offset:1408
    ds_read_u16 v86, v42 offset:1408
    s_waitcnt lgkmcnt(11)
    v_lshl_or_b32 v88, v65, 16, v64
    v_lshl_or_b32 v89, v67, 16, v66
    v_lshl_or_b32 v90, v69, 16, v68
    v_lshl_or_b32 v91, v71, 16, v70
    v_lshl_or_b32 v92, v66, 16, v65
    v_lshl_or_b32 v93, v68, 16, v67
    v_lshl_or_b32 v94, v70, 16, v69
    v_lshl_or_b32 v95, v72, 16, v71
    ds_write_b128 v43, v[88:91] offset:12496
    ds_write_b128 v43, v[92:95] offset:8336
    v_mov_b32 v96, v89
    v_mov_b32 v97, v90
    v_mov_b32 v98, v91
    v_lshl_or_b32 v99, v73, 16, v72
    v_mov_b32 v100, v93
    v_mov_b32 v101, v94
    v_mov_b32 v102, v95
    v_lshl_or_b32 v103, v74, 16, v73
    ds_write_b128 v43, v[96:99] offset:4176
    ds_write_b128 v43, v[100:103] offset:16
    s_waitcnt lgkmcnt(4)
    v_lshl_or_b32 v104, v77, 16, v76
    v_lshl_or_b32 v105, v79, 16, v78
    v_lshl_or_b32 v106, v81, 16, v80
    v_lshl_or_b32 v107, v83, 16, v82
    v_lshl_or_b32 v108, v78, 16, v77
    v_lshl_or_b32 v109, v80, 16, v79
    v_lshl_or_b32 v110, v82, 16, v81
    v_lshl_or_b32 v111, v84, 16, v83
    ds_write_b128 v43, v[104:107] offset:29136
    ds_write_b128 v43, v[108:111] offset:24976
    v_mov_b32 v112, v105
    v_mov_b32 v113, v106
    v_mov_b32 v114, v107
    v_lshl_or_b32 v115, v85, 16, v84
    v_mov_b32 v116, v109
    v_mov_b32 v117, v110
    v_mov_b32 v118, v111
    v_lshl_or_b32 v119, v86, 16, v85
    ds_write_b128 v43, v[112:115] offset:20816
    ds_write_b128 v43, v[116:119] offset:16656
    s_waitcnt lgkmcnt(0)
    v_mov_b32 v120, 86416
    v_mov_b32 v121, 1
    s_mov_b64 exec, 1
    ds_add_u32 v120, v121
    s_mov_b64 exec, -1
    s_mov_b32 s41, 0
L_e1_loop:
    s_waitcnt vmcnt(0)
    s_mov_b64 s[42:43], 0
    v_cmp_ne_u32 vcc, s33, v46
    s_or_b64 s[42:43], s[42:43], vcc
    v_cmp_ne_u32 vcc, s33, v50
    s_or_b64 s[42:43], s[42:43], vcc
    v_cmp_ne_u32 vcc, s33, v54
    s_or_b64 s[42:43], s[42:43], vcc
    v_cmp_ne_u32 vcc, s33, v58
    s_or_b64 s[42:43], s[42:43], vcc
    s_cmp_eq_u64 s[42:43], 0
    s_cbranch_scc1 L_e1_done
    s_add_u32 s41, s41, 1
    s_cmp_gt_u32 s41, 100000
    s_cbranch_scc1 L_e1_done
    s_sleep 2
    v_cmp_ne_u32 vcc, s33, v46
    s_mov_b64 exec, vcc
    s_cbranch_execz L_e1_skip0
    global_load_dwordx4 v[44:47], v3, s[52:53] sc1
L_e1_skip0:
    s_mov_b64 exec, -1
    v_cmp_ne_u32 vcc, s33, v50
    s_mov_b64 exec, vcc
    s_cbranch_execz L_e1_skip1
    global_load_dwordx4 v[48:51], v8, s[52:53] sc1
L_e1_skip1:
    s_mov_b64 exec, -1
    v_cmp_ne_u32 vcc, s33, v54
    s_mov_b64 exec, vcc
    s_cbranch_execz L_e1_skip2
    global_load_dwordx4 v[52:55], v3, s[58:59] sc1
L_e1_skip2:
    s_mov_b64 exec, -1
    v_cmp_ne_u32 vcc, s33, v58
    s_mov_b64 exec, vcc
    s_cbranch_execz L_e1_skip3
    global_load_dwordx4 v[56:59], v8, s[58:59] sc1
L_e1_skip3:
    s_mov_b64 exec, -1
    s_branch L_e1_loop
L_e1_done:
    v_max_u32 v60, v47, v51
    v_min_u32 v61, v47, v51
    v_max_u32 v62, v55, v59
    v_min_u32 v63, v55, v59
    v_max_u32 v61, v61, v63
    v_med3_u32 v61, v60, v62, v61
    v_max_u32 v60, v60, v62
    v_lshlrev_b32 v16, 3, v2
    v_add_u32 v16, 86608, v16
    ds_write_b64 v16, v[60:61]
    v_mov_b32 v62, 86420
    v_mov_b32 v63, 1
    s_mov_b64 exec, 1
    ds_add_u32 v62, v63
    s_mov_b64 exec, -1
    ds_write_b64 v4, v[44:45] offset:5152
    ds_write_b64 v4, v[44:45] offset:520
    ds_write_b64 v4, v[48:49] offset:6176
    ds_write_b64 v4, v[48:49] offset:1544
    ds_write_b64 v4, v[52:53] offset:7200
    ds_write_b64 v4, v[52:53] offset:2568
    ds_write_b64 v4, v[56:57] offset:8224
    ds_write_b64 v4, v[56:57] offset:3592
    v_mov_b32 v62, 86424
    v_mov_b32 v63, 1
    s_mov_b64 exec, 1
    ds_add_u32 v62, v63
    s_mov_b64 exec, -1
    s_cmp_ge_u32 s2, 224
    s_cbranch_scc1 L_t_noffn
    s_add_u32 s38, s2, 6
    s_bfe_u32 s38, s38, 0x20001
    s_lshr_b32 s39, s2, 3
    s_lshl_b32 s39, s39, 1
    s_bitcmp1_b32 s2, 0
    s_addc_u32 s39, s39, 0
    s_lshl_b32 s39, s39, 12
    s_lshl_b32 s40, s38, 10
    s_add_u32 s39, s39, s40
    s_lshl_b32 s40, s35, 8
    s_add_u32 s39, s39, s40
    s_add_u32 s39, s39, 0x10000
    s_add_u32 s60, s30, s39
    s_addc_u32 s61, s31, 0
    v_and_b32 v16, 1, v1
    v_lshlrev_b32 v16, 8, v16
    v_lshrrev_b32 v17, 4, v1
    v_lshl_add_u32 v16, v17, 4, v16
    v_add_u32 v16, 110032, v16
    v_bfe_u32 v18, v1, 2, 2
    v_lshl_add_u32 v18, v17, 2, v18
    v_lshlrev_b32 v18, 6, v18
    v_and_b32 v19, 3, v1
    v_lshl_add_u32 v18, v19, 3, v18
    v_and_b32 v19, 1, v17
    s_and_b32 s40, s35, 1
    v_xor_b32 v19, s40, v19
    v_lshl_add_u32 v18, v19, 5, v18
    s_lshr_b32 s40, s35, 1
    s_lshl_b32 s40, s40, 13
    s_add_u32 s40, s40, 111056
    v_add_u32 v18, s40, v18
    v_lshlrev_b32 v19, 4, v1
    v_mov_b32 v20, 86368
    s_mov_b32 s41, 0
L_idxt_lw:
    ds_read_b32 v21, v20
    s_add_u32 s41, s41, 1
    s_cmp_gt_u32 s41, 1000000
    s_cbranch_scc1 L_idxt_lwd
    s_waitcnt lgkmcnt(0)
    v_cmp_gt_u32 vcc, 1, v21
    s_nop 0
    s_cbranch_vccz L_idxt_lwd
    s_sleep 1
    s_branch L_idxt_lw
L_idxt_lwd:
    s_waitcnt lgkmcnt(0)
    v_mov_b32 v20, 86336
    ds_read_b64 v[60:61], v20
    v_and_b32 v21, 0x7f, v2
    s_lshl_b32 s40, s38, 7
    v_add_u32 v22, s40, v21
    v_lshlrev_b32 v22, 1, v22
    v_cmp_gt_u32 vcc, 0x80, v2
    s_waitcnt lgkmcnt(0)
    s_nop 0
    v_cndmask_b32 v23, v61, v60, vcc
    v_lshl_add_u32 v22, v23, 10, v22
    global_load_ushort v24, v22, s[4:5]
    v_lshlrev_b32 v23, 3, v23
    v_add_u32 v23, 4096, v23
    global_load_dwordx2 v[26:27], v23, s[30:31] sc1
    v_and_b32 v28, 0x63, v21
    v_bfe_u32 v29, v21, 2, 2
    v_lshl_add_u32 v28, v29, 3, v28
    v_bfe_u32 v29, v21, 4, 1
    v_lshl_add_u32 v28, v29, 2, v28
    v_lshrrev_b32 v29, 7, v2
    v_lshl_add_u32 v28, v29, 7, v28
    v_lshlrev_b32 v28, 1, v28
    v_add_u32 v28, 110032, v28
    s_mov_b32 s41, 0
L_st_loop:
    s_waitcnt vmcnt(0)
    v_cmp_ne_u32 vcc, s33, v27
    s_nop 0
    s_cbranch_vccz L_st_done
    s_add_u32 s41, s41, 1
    s_cmp_gt_u32 s41, 100000
    s_cbranch_scc1 L_st_done
    global_load_dwordx2 v[26:27], v23, s[30:31] sc1
    s_branch L_st_loop
L_st_done:
    v_and_b32 v30, s62, v26
    v_lshlrev_b32 v26, 16, v26
    v_rcp_f32 v31, v30
    v_lshlrev_b32 v24, 16, v24
    v_sub_f32 v24, v24, v26
    v_fma_f32 v29, -v30, v31, 1.0
    v_cvt_pk_bf16_f32 v24, v24, v24
    v_fma_f32 v31, v31, v29, v31
    v_lshlrev_b32 v24, 16, v24
    v_mul_f32 v24, v24, v31
    v_cvt_pk_bf16_f32 v24, v24, v24
    ds_write_b16 v28, v24
    s_waitcnt lgkmcnt(0)
    v_mov_b32 v20, 86364
    v_mov_b32 v21, 1
    s_mov_b64 exec, 1
    ds_add_u32 v20, v21
    s_mov_b64 exec, -1
    v_mov_b32 v20, 86372
    s_mov_b32 s41, 0
L_wt_lw:
    ds_read_b32 v21, v20
    s_add_u32 s41, s41, 1
    s_cmp_gt_u32 s41, 1000000
    s_cbranch_scc1 L_wt_lwd
    s_waitcnt lgkmcnt(0)
    v_cmp_gt_u32 vcc, 1, v21
    s_nop 0
    s_cbranch_vccz L_wt_lwd
    s_sleep 1
    s_branch L_wt_lw
L_wt_lwd:
    s_waitcnt lgkmcnt(0)
    v_mov_b32 v20, 86364
    s_mov_b32 s41, 0
L_xs_lw:
    ds_read_b32 v21, v20
    s_add_u32 s41, s41, 1
    s_cmp_gt_u32 s41, 1000000
    s_cbranch_scc1 L_xs_lwd
    s_waitcnt lgkmcnt(0)
    v_cmp_gt_u32 vcc, 4, v21
    s_nop 0
    s_cbranch_vccz L_xs_lwd
    s_branch L_xs_lw
L_xs_lwd:
    s_waitcnt lgkmcnt(0)
    ds_read_b128 v[132:135], v16 offset:0
    ds_read_b64_tr_b16 v[136:137], v18 offset:0
    ds_read_b64_tr_b16 v[138:139], v18 offset:1024
    ds_read_b128 v[140:143], v16 offset:64
    ds_read_b64_tr_b16 v[144:145], v18 offset:2048
    ds_read_b64_tr_b16 v[146:147], v18 offset:3072
    ds_read_b128 v[148:151], v16 offset:128
    ds_read_b64_tr_b16 v[152:153], v18 offset:4096
    ds_read_b64_tr_b16 v[154:155], v18 offset:5120
    ds_read_b128 v[156:159], v16 offset:192
    ds_read_b64_tr_b16 v[160:161], v18 offset:6144
    ds_read_b64_tr_b16 v[162:163], v18 offset:7168
    s_waitcnt lgkmcnt(9)
    v_mfma_f32_16x16x32_bf16 v[116:119], v[132:135], v[136:139], 0
    s_waitcnt lgkmcnt(6)
    v_mfma_f32_16x16x32_bf16 v[116:119], v[140:143], v[144:147], v[116:119]
    s_waitcnt lgkmcnt(3)
    v_mfma_f32_16x16x32_bf16 v[116:119], v[148:151], v[152:155], v[116:119]
    s_waitcnt lgkmcnt(0)
    v_mfma_f32_16x16x32_bf16 v[116:119], v[156:159], v[160:163], v[116:119]
    s_nop 7
    v_mov_b32 v118, s33
    s_mov_b32 exec_lo, 0xffff
    s_mov_b32 exec_hi, 0
    global_store_dwordx4 v19, v[116:119], s[60:61] sc1
    s_lshl_b32 s40, s35, 7
    s_add_u32 s40, s40, 110544
    v_lshl_add_u32 v19, v1, 3, s40
    ds_write_b64 v19, v[116:117]
    s_mov_b64 exec, -1
    s_waitcnt lgkmcnt(0)
    v_mov_b32 v20, 86376
    v_mov_b32 v21, 1
    s_mov_b64 exec, 1
    ds_add_u32 v20, v21
    s_mov_b64 exec, -1
L_t_noffn:
    v_mov_b32 v16, 86352
    s_mov_b32 s41, 0
L_cnt_lw:
    ds_read_b32 v17, v16
    s_add_u32 s41, s41, 1
    s_cmp_gt_u32 s41, 1000000
    s_cbranch_scc1 L_cnt_lwd
    s_waitcnt lgkmcnt(0)
    v_cmp_gt_u32 vcc, 4, v17
    s_nop 0
    s_cbranch_vccz L_cnt_lwd
    s_sleep 2
    s_branch L_cnt_lw
L_cnt_lwd:
    s_waitcnt lgkmcnt(0)
    ds_read_u16 v64, v5 offset:8320
    ds_read_u16 v65, v5 offset:9360
    ds_read_u16 v66, v5 offset:10400
    ds_read_u16 v67, v5 offset:11440
    ds_read_u16 v80, v5 offset:0
    ds_read_u16 v81, v5 offset:1040
    ds_read_u16 v82, v5 offset:2080
    ds_read_u16 v83, v5 offset:3120
    ds_read_u16 v68, v5 offset:8576
    ds_read_u16 v69, v5 offset:9616
    ds_read_u16 v70, v5 offset:10656
    ds_read_u16 v71, v5 offset:11696
    ds_read_u16 v84, v5 offset:256
    ds_read_u16 v85, v5 offset:1296
    ds_read_u16 v86, v5 offset:2336
    ds_read_u16 v87, v5 offset:3376
    ds_read_u16 v72, v5 offset:8832
    ds_read_u16 v73, v5 offset:9872
    ds_read_u16 v74, v5 offset:10912
    ds_read_u16 v75, v5 offset:11952
    ds_read_u16 v88, v5 offset:512
    ds_read_u16 v89, v5 offset:1552
    ds_read_u16 v90, v5 offset:2592
    ds_read_u16 v91, v5 offset:3632
    ds_read_u16 v76, v5 offset:9088
    ds_read_u16 v77, v5 offset:10128
    ds_read_u16 v78, v5 offset:11168
    ds_read_u16 v79, v5 offset:12208
    ds_read_u16 v92, v5 offset:768
    ds_read_u16 v93, v5 offset:1808
    ds_read_u16 v94, v5 offset:2848
    ds_read_u16 v95, v5 offset:3888
    s_waitcnt lgkmcnt(15)
    v_lshlrev_b32 v64, 16, v64
    v_lshlrev_b32 v80, 16, v80
    v_lshlrev_b32 v65, 16, v65
    v_lshlrev_b32 v81, 16, v81
    v_lshlrev_b32 v66, 16, v66
    v_lshlrev_b32 v82, 16, v82
    v_lshlrev_b32 v67, 16, v67
    v_lshlrev_b32 v83, 16, v83
    s_waitcnt lgkmcnt(15)
    v_lshlrev_b32 v68, 16, v68
    v_lshlrev_b32 v84, 16, v84
    v_lshlrev_b32 v69, 16, v69
    v_lshlrev_b32 v85, 16, v85
    v_lshlrev_b32 v70, 16, v70
    v_lshlrev_b32 v86, 16, v86
    v_lshlrev_b32 v71, 16, v71
    v_lshlrev_b32 v87, 16, v87
    s_waitcnt lgkmcnt(8)
    v_lshlrev_b32 v72, 16, v72
    v_lshlrev_b32 v88, 16, v88
    v_lshlrev_b32 v73, 16, v73
    v_lshlrev_b32 v89, 16, v89
    v_lshlrev_b32 v74, 16, v74
    v_lshlrev_b32 v90, 16, v90
    v_lshlrev_b32 v75, 16, v75
    v_lshlrev_b32 v91, 16, v91
    s_waitcnt lgkmcnt(0)
    v_lshlrev_b32 v76, 16, v76
    v_lshlrev_b32 v92, 16, v92
    v_lshlrev_b32 v77, 16, v77
    v_lshlrev_b32 v93, 16, v93
    v_lshlrev_b32 v78, 16, v78
    v_lshlrev_b32 v94, 16, v94
    v_lshlrev_b32 v79, 16, v79
    v_lshlrev_b32 v95, 16, v95
    v_lshlrev_b32 v112, 16, v12
    v_pk_mul_f32 v[96:97], v[64:65], v[112:113] op_sel_hi:[1,0]
    v_pk_mul_f32 v[98:99], v[66:67], v[112:113] op_sel_hi:[1,0]
    v_cvt_pk_bf16_f32 v114, v96, v97
    v_cvt_pk_bf16_f32 v115, v98, v99
    v_lshlrev_b32 v96, 16, v114
    v_and_b32 v97, s62, v114
    v_lshlrev_b32 v98, 16, v115
    v_and_b32 v99, s62, v115
    v_lshlrev_b32 v112, 16, v13
    v_pk_mul_f32 v[100:101], v[68:69], v[112:113] op_sel_hi:[1,0]
    v_pk_mul_f32 v[102:103], v[70:71], v[112:113] op_sel_hi:[1,0]
    v_cvt_pk_bf16_f32 v114, v100, v101
    v_cvt_pk_bf16_f32 v115, v102, v103
    v_lshlrev_b32 v100, 16, v114
    v_and_b32 v101, s62, v114
    v_lshlrev_b32 v102, 16, v115
    v_and_b32 v103, s62, v115
    v_lshlrev_b32 v112, 16, v14
    v_pk_mul_f32 v[104:105], v[72:73], v[112:113] op_sel_hi:[1,0]
    v_pk_mul_f32 v[106:107], v[74:75], v[112:113] op_sel_hi:[1,0]
    v_cvt_pk_bf16_f32 v114, v104, v105
    v_cvt_pk_bf16_f32 v115, v106, v107
    v_lshlrev_b32 v104, 16, v114
    v_and_b32 v105, s62, v114
    v_lshlrev_b32 v106, 16, v115
    v_and_b32 v107, s62, v115
    v_lshlrev_b32 v112, 16, v15
    v_pk_mul_f32 v[108:109], v[76:77], v[112:113] op_sel_hi:[1,0]
    v_pk_mul_f32 v[110:111], v[78:79], v[112:113] op_sel_hi:[1,0]
    v_cvt_pk_bf16_f32 v114, v108, v109
    v_cvt_pk_bf16_f32 v115, v110, v111
    v_lshlrev_b32 v108, 16, v114
    v_and_b32 v109, s62, v114
    v_lshlrev_b32 v110, 16, v115
    v_and_b32 v111, s62, v115
    s_sleep 30
    v_mov_b32 v16, 86368
    s_mov_b32 s41, 0
L_idxw_lw:
    ds_read_b32 v17, v16
    s_add_u32 s41, s41, 1
    s_cmp_gt_u32 s41, 1000000
    s_cbranch_scc1 L_idxw_lwd
    s_waitcnt lgkmcnt(0)
    v_cmp_gt_u32 vcc, 1, v17
    s_nop 0
    s_cbranch_vccz L_idxw_lwd
    s_sleep 1
    s_branch L_idxw_lw
L_idxw_lwd:
    s_waitcnt lgkmcnt(0)
    v_mov_b32 v17, 86336
    ds_read_b64 v[60:61], v17
    global_load_dwordx4 v[44:47], v3, s[54:55] sc1
    global_load_dwordx4 v[48:51], v8, s[54:55] sc1
    global_load_dwordx4 v[52:55], v3, s[56:57] sc1
    global_load_dwordx4 v[56:59], v8, s[56:57] sc1
    s_mov_b32 s41, 0
L_e2_loop:
    s_waitcnt vmcnt(0)
    s_mov_b64 s[42:43], 0
    v_cmp_ne_u32 vcc, s33, v46
    s_or_b64 s[42:43], s[42:43], vcc
    v_cmp_ne_u32 vcc, s33, v50
    s_or_b64 s[42:43], s[42:43], vcc
    v_cmp_ne_u32 vcc, s33, v54
    s_or_b64 s[42:43], s[42:43], vcc
    v_cmp_ne_u32 vcc, s33, v58
    s_or_b64 s[42:43], s[42:43], vcc
    s_cmp_eq_u64 s[42:43], 0
    s_cbranch_scc1 L_e2_done
    s_add_u32 s41, s41, 1
    s_cmp_gt_u32 s41, 100000
    s_cbranch_scc1 L_e2_done
    s_sleep 2
    v_cmp_ne_u32 vcc, s33, v46
    s_mov_b64 exec, vcc
    s_cbranch_execz L_e2_skip0
    global_load_dwordx4 v[44:47], v3, s[54:55] sc1
L_e2_skip0:
    s_mov_b64 exec, -1
    v_cmp_ne_u32 vcc, s33, v50
    s_mov_b64 exec, vcc
    s_cbranch_execz L_e2_skip1
    global_load_dwordx4 v[48:51], v8, s[54:55] sc1
L_e2_skip1:
    s_mov_b64 exec, -1
    v_cmp_ne_u32 vcc, s33, v54
    s_mov_b64 exec, vcc
    s_cbranch_execz L_e2_skip2
    global_load_dwordx4 v[52:55], v3, s[56:57] sc1
L_e2_skip2:
    s_mov_b64 exec, -1
    v_cmp_ne_u32 vcc, s33, v58
    s_mov_b64 exec, vcc
    s_cbranch_execz L_e2_skip3
    global_load_dwordx4 v[56:59], v8, s[56:57] sc1
L_e2_skip3:
    s_mov_b64 exec, -1
    s_branch L_e2_loop
L_e2_done:
    s_or_b32 s39, s2, s35
    s_cmp_lg_u32 s39, 0
    s_cbranch_scc1 L_noepoch
    v_mov_b32 v16, 0
    v_mov_b32 v17, s33
    s_mov_b64 exec, 1
    global_store_dword v16, v17, s[30:31] sc1
    s_mov_b64 exec, -1
L_noepoch:
    s_mov_b32 s39, 0x05040100
    s_mov_b32 s40, 0x07060302
    s_waitcnt lgkmcnt(0)
    v_add_u32 v62, 0, v6
    v_cmp_ne_u32 vcc, v62, v60
    v_cmp_ne_u32 s[42:43], v62, v61
    s_and_b64 s[68:69], vcc, s[42:43]
    v_add_u32 v62, 1, v6
    v_cmp_ne_u32 vcc, v62, v60
    v_cmp_ne_u32 s[42:43], v62, v61
    s_and_b64 s[36:37], vcc, s[42:43]
    v_lshlrev_b32 v112, 16, v44
    v_and_b32 v113, s62, v44
    v_lshlrev_b32 v114, 16, v45
    v_and_b32 v115, s62, v45
    v_pk_add_f32 v[112:113], v[112:113], v[96:97]
    v_pk_add_f32 v[114:115], v[114:115], v[98:99]
    v_cvt_pk_bf16_f32 v116, v112, v113
    v_cvt_pk_bf16_f32 v117, v114, v115
    v_lshlrev_b32 v112, 16, v116
    v_and_b32 v113, s62, v116
    v_lshlrev_b32 v114, 16, v117
    v_and_b32 v115, s62, v117
    v_pk_add_f32 v[112:113], v[112:113], v[80:81]
    v_pk_add_f32 v[114:115], v[114:115], v[82:83]
    v_cvt_pk_bf16_f32 v116, v112, v113
    v_cvt_pk_bf16_f32 v117, v114, v115
    v_lshlrev_b32 v112, 16, v116
    v_and_b32 v113, s62, v116
    v_lshlrev_b32 v114, 16, v117
    v_and_b32 v115, s62, v117
    v_pk_add_f32 v[112:113], v[112:113], v[64:65]
    v_pk_add_f32 v[114:115], v[114:115], v[66:67]
    v_cvt_pk_bf16_f32 v116, v112, v113
    v_cvt_pk_bf16_f32 v117, v114, v115
    v_cndmask_b32 v118, v117, v116, s[66:67]
    v_cndmask_b32 v119, v116, v117, s[66:67]
    s_nop 0
    v_mov_b32_dpp v118, v118 quad_perm:[2,3,0,1] row_mask:0xf bank_mask:0xf
    v_cndmask_b32 v120, v119, v118, s[66:67]
    v_cndmask_b32 v121, v118, v119, s[66:67]
    v_perm_b32 v124, v121, v120, s39
    v_perm_b32 v125, v121, v120, s40
    s_mov_b64 exec, s[68:69]
    global_store_dword v7, v124, s[28:29] offset:0 nt
    s_mov_b64 exec, s[36:37]
    global_store_dword v7, v125, s[28:29] offset:1024 nt
    s_mov_b64 exec, -1
    v_lshlrev_b32 v112, 16, v48
    v_and_b32 v113, s62, v48
    v_lshlrev_b32 v114, 16, v49
    v_and_b32 v115, s62, v49
    v_pk_add_f32 v[112:113], v[112:113], v[100:101]
    v_pk_add_f32 v[114:115], v[114:115], v[102:103]
    v_cvt_pk_bf16_f32 v116, v112, v113
    v_cvt_pk_bf16_f32 v117, v114, v115
    v_lshlrev_b32 v112, 16, v116
    v_and_b32 v113, s62, v116
    v_lshlrev_b32 v114, 16, v117
    v_and_b32 v115, s62, v117
    v_pk_add_f32 v[112:113], v[112:113], v[84:85]
    v_pk_add_f32 v[114:115], v[114:115], v[86:87]
    v_cvt_pk_bf16_f32 v116, v112, v113
    v_cvt_pk_bf16_f32 v117, v114, v115
    v_lshlrev_b32 v112, 16, v116
    v_and_b32 v113, s62, v116
    v_lshlrev_b32 v114, 16, v117
    v_and_b32 v115, s62, v117
    v_pk_add_f32 v[112:113], v[112:113], v[68:69]
    v_pk_add_f32 v[114:115], v[114:115], v[70:71]
    v_cvt_pk_bf16_f32 v116, v112, v113
    v_cvt_pk_bf16_f32 v117, v114, v115
    v_cndmask_b32 v118, v117, v116, s[66:67]
    v_cndmask_b32 v119, v116, v117, s[66:67]
    s_nop 0
    v_mov_b32_dpp v118, v118 quad_perm:[2,3,0,1] row_mask:0xf bank_mask:0xf
    v_cndmask_b32 v120, v119, v118, s[66:67]
    v_cndmask_b32 v121, v118, v119, s[66:67]
    v_perm_b32 v126, v121, v120, s39
    v_perm_b32 v127, v121, v120, s40
    s_mov_b64 exec, s[68:69]
    global_store_dword v7, v126, s[28:29] offset:256 nt
    s_mov_b64 exec, s[36:37]
    global_store_dword v7, v127, s[28:29] offset:1280 nt
    s_mov_b64 exec, -1
    v_lshlrev_b32 v112, 16, v52
    v_and_b32 v113, s62, v52
    v_lshlrev_b32 v114, 16, v53
    v_and_b32 v115, s62, v53
    v_pk_add_f32 v[112:113], v[112:113], v[104:105]
    v_pk_add_f32 v[114:115], v[114:115], v[106:107]
    v_cvt_pk_bf16_f32 v116, v112, v113
    v_cvt_pk_bf16_f32 v117, v114, v115
    v_lshlrev_b32 v112, 16, v116
    v_and_b32 v113, s62, v116
    v_lshlrev_b32 v114, 16, v117
    v_and_b32 v115, s62, v117
    v_pk_add_f32 v[112:113], v[112:113], v[88:89]
    v_pk_add_f32 v[114:115], v[114:115], v[90:91]
    v_cvt_pk_bf16_f32 v116, v112, v113
    v_cvt_pk_bf16_f32 v117, v114, v115
    v_lshlrev_b32 v112, 16, v116
    v_and_b32 v113, s62, v116
    v_lshlrev_b32 v114, 16, v117
    v_and_b32 v115, s62, v117
    v_pk_add_f32 v[112:113], v[112:113], v[72:73]
    v_pk_add_f32 v[114:115], v[114:115], v[74:75]
    v_cvt_pk_bf16_f32 v116, v112, v113
    v_cvt_pk_bf16_f32 v117, v114, v115
    v_cndmask_b32 v118, v117, v116, s[66:67]
    v_cndmask_b32 v119, v116, v117, s[66:67]
    s_nop 0
    v_mov_b32_dpp v118, v118 quad_perm:[2,3,0,1] row_mask:0xf bank_mask:0xf
    v_cndmask_b32 v120, v119, v118, s[66:67]
    v_cndmask_b32 v121, v118, v119, s[66:67]
    v_perm_b32 v128, v121, v120, s39
    v_perm_b32 v129, v121, v120, s40
    s_mov_b64 exec, s[68:69]
    global_store_dword v7, v128, s[28:29] offset:512 nt
    s_mov_b64 exec, s[36:37]
    global_store_dword v7, v129, s[28:29] offset:1536 nt
    s_mov_b64 exec, -1
    v_lshlrev_b32 v112, 16, v56
    v_and_b32 v113, s62, v56
    v_lshlrev_b32 v114, 16, v57
    v_and_b32 v115, s62, v57
    v_pk_add_f32 v[112:113], v[112:113], v[108:109]
    v_pk_add_f32 v[114:115], v[114:115], v[110:111]
    v_cvt_pk_bf16_f32 v116, v112, v113
    v_cvt_pk_bf16_f32 v117, v114, v115
    v_lshlrev_b32 v112, 16, v116
    v_and_b32 v113, s62, v116
    v_lshlrev_b32 v114, 16, v117
    v_and_b32 v115, s62, v117
    v_pk_add_f32 v[112:113], v[112:113], v[92:93]
    v_pk_add_f32 v[114:115], v[114:115], v[94:95]
    v_cvt_pk_bf16_f32 v116, v112, v113
    v_cvt_pk_bf16_f32 v117, v114, v115
    v_lshlrev_b32 v112, 16, v116
    v_and_b32 v113, s62, v116
    v_lshlrev_b32 v114, 16, v117
    v_and_b32 v115, s62, v117
    v_pk_add_f32 v[112:113], v[112:113], v[76:77]
    v_pk_add_f32 v[114:115], v[114:115], v[78:79]
    v_cvt_pk_bf16_f32 v116, v112, v113
    v_cvt_pk_bf16_f32 v117, v114, v115
    v_cndmask_b32 v118, v117, v116, s[66:67]
    v_cndmask_b32 v119, v116, v117, s[66:67]
    s_nop 0
    v_mov_b32_dpp v118, v118 quad_perm:[2,3,0,1] row_mask:0xf bank_mask:0xf
    v_cndmask_b32 v120, v119, v118, s[66:67]
    v_cndmask_b32 v121, v118, v119, s[66:67]
    v_perm_b32 v130, v121, v120, s39
    v_perm_b32 v131, v121, v120, s40
    s_mov_b64 exec, s[68:69]
    global_store_dword v7, v130, s[28:29] offset:768 nt
    s_mov_b64 exec, s[36:37]
    global_store_dword v7, v131, s[28:29] offset:1792 nt
    s_mov_b64 exec, -1
    s_branch L_fin
L_aux2:
    s_mov_b32 s60, 0x3fb8aa00
    s_mov_b32 s61, 0x36eca570
    s_mov_b32 s62, 0xffff0000
    s_mov_b32 s63, 0x80000000
    s_waitcnt lgkmcnt(0)
    s_load_dword s33, s[30:31], 0
    s_lshl_b32 s39, s3, 4
    s_add_u32 s39, s39, 0xa00000
    s_add_u32 s58, s30, s39
    s_addc_u32 s59, s31, 0
    v_lshrrev_b32 v16, 1, v1
    v_lshlrev_b32 v16, 13, v16
    v_and_b32 v24, 1, v1
    v_lshl_add_u32 v16, v24, 12, v16
    v_add_u32 v17, 0x40000, v16
    v_bfe_u32 v25, v1, 1, 1
    v_cmp_eq_u32 s[66:67], 1, v24
    s_lshl_b32 s39, s3, 1
    v_add_u32 v27, s39, v25
    v_lshlrev_b32 v27, 1, v27
    global_load_ushort v30, v27, s[16:17]
    s_waitcnt lgkmcnt(0)
    s_add_u32 s33, s33, 0x9e3779b9
    s_add_u32 s35, s2, 6
    s_bfe_u32 s35, s35, 0x20001
    s_lshr_b32 s36, s2, 3
    s_lshl_b32 s36, s36, 1
    s_bitcmp1_b32 s2, 0
    s_addc_u32 s36, s36, 0
    v_lshrrev_b32 v20, 2, v1
    v_and_b32 v21, 3, v1
    v_bfe_u32 v18, v20, 2, 1
    v_lshlrev_b32 v18, 1, v18
    v_xor_b32 v21, v21, v18
    s_lshl_b32 s39, s35, 7
    v_add_u32 v20, s39, v20
    v_mul_u32_u24 v20, 3584, v20
    v_lshl_add_u32 v20, v21, 4, v20
    s_lshl_b32 s39, s36, 6
    v_add_u32 v22, s39, v20
    v_lshrrev_b32 v20, 4, v1
    v_lshlrev_b32 v20, 10, v20
    v_and_b32 v21, 15, v1
    v_lshl_add_u32 v20, v21, 4, v20
    s_lshl_b32 s39, s36, 15
    s_lshl_b32 s40, s35, 8
    s_add_u32 s39, s39, s40
    v_add_u32 v23, s39, v20
    v_and_b32 v20, 7, v1
    v_add_u32 v20, 248, v20
    v_mov_b32 v21, s2
    v_cmp_gt_u32 vcc, 8, v1
    s_nop 1
    v_cndmask_b32 v20, v21, v20, vcc
    v_lshlrev_b32 v20, 6, v20
    v_add_u32 v20, 32768, v20
    s_mov_b32 exec_lo, 0x100
    s_mov_b32 exec_hi, 0
    global_load_dword v154, v20, s[30:31] sc1
    s_mov_b64 exec, -1
    s_barrier
    s_barrier
    s_cmp_ge_u32 s2, 224
    s_cbranch_scc1 L_a2_nodma0
    v_mov_b32 v18, 86360
    s_mov_b32 s41, 0
L_dmaw0_lw:
    ds_read_b32 v19, v18
    s_add_u32 s41, s41, 1
    s_cmp_gt_u32 s41, 1000000
    s_cbranch_scc1 L_dmaw0_lwd
    s_waitcnt lgkmcnt(0)
    v_cmp_gt_u32 vcc, 4, v19
    s_nop 0
    s_cbranch_vccz L_dmaw0_lwd
    s_sleep 1
    s_branch L_dmaw0_lw
L_dmaw0_lwd:
    s_waitcnt lgkmcnt(0)
    s_mov_b32 s40, 111056
    s_mov_b32 s41, 8
L_dma:
    s_mov_b32 m0, s40
    s_add_u32 s39, s40, 8192
    global_load_lds_dwordx4 v22, s[22:23] nt
    s_mov_b32 m0, s39
    s_add_u32 s40, s40, 1024
    global_load_lds_dwordx4 v22, s[24:25] nt
    v_add_u32 v22, 57344, v22
    s_sub_u32 s41, s41, 1
    s_cmp_lg_u32 s41, 0
    s_cbranch_scc1 L_dma
L_a2_nodma0:
    s_cmp_ge_u32 s2, 224
    s_cbranch_scc1 L_a2_nodma1
    v_mov_b32 v18, 86368
    s_mov_b32 s41, 0
L_dmaw1_lw:
    ds_read_b32 v19, v18
    s_add_u32 s41, s41, 1
    s_cmp_gt_u32 s41, 1000000
    s_cbranch_scc1 L_dmaw1_lwd
    s_waitcnt lgkmcnt(0)
    v_cmp_gt_u32 vcc, 1, v19
    s_nop 0
    s_cbranch_vccz L_dmaw1_lwd
    s_sleep 1
    s_branch L_dmaw1_lw
L_dmaw1_lwd:
    s_waitcnt lgkmcnt(0)
    s_mov_b32 s40, 127440
    s_mov_b32 s41, 8
L_dma2:
    s_mov_b32 m0, s40
    s_add_u32 s40, s40, 1024
    global_load_lds_dwordx4 v23, s[26:27] nt
    v_add_u32 v23, 4096, v23
    s_sub_u32 s41, s41, 1
    s_cmp_lg_u32 s41, 0
    s_cbranch_scc1 L_dma2
L_a2_nodma1:
    s_cmp_ge_u32 s2, 224
    s_cbranch_scc1 L_a2_w
    s_waitcnt vmcnt(8)
    v_mov_b32 v18, 86372
    v_mov_b32 v19, 1
    s_mov_b64 exec, 1
    ds_add_u32 v18, v19
    s_mov_b64 exec, -1
    s_waitcnt vmcnt(0)
    v_mov_b32 v18, 86384
    v_mov_b32 v19, 1
    s_mov_b64 exec, 1
    ds_add_u32 v18, v19
    s_mov_b64 exec, -1
L_a2_w:
    v_mov_b32 v18, 86368
    s_mov_b32 s41, 0
L_idx2_lw:
    ds_read_b32 v19, v18
    s_add_u32 s41, s41, 1
    s_cmp_gt_u32 s41, 1000000
    s_cbranch_scc1 L_idx2_lwd
    s_waitcnt lgkmcnt(0)
    v_cmp_gt_u32 vcc, 1, v19
    s_nop 0
    s_cbranch_vccz L_idx2_lwd
    s_sleep 2
    s_branch L_idx2_lw
L_idx2_lwd:
    s_waitcnt lgkmcnt(0)
    v_mov_b32 v18, 86424
    s_mov_b32 s41, 0
L_u2_lw:
    ds_read_b32 v19, v18
    s_add_u32 s41, s41, 1
    s_cmp_gt_u32 s41, 1000000
    s_cbranch_scc1 L_u2_lwd
    s_waitcnt lgkmcnt(0)
    v_cmp_gt_u32 vcc, 4, v19
    s_nop 0
    s_cbranch_vccz L_u2_lwd
    s_sleep 1
    s_branch L_u2_lw
L_u2_lwd:
    s_waitcnt lgkmcnt(0)
    v_mov_b32 v18, 86336
    ds_read_b128 v[44:47], v18
    s_waitcnt lgkmcnt(0)
    v_cndmask_b32 v26, v44, v45, s[66:67]
    v_cndmask_b32 v46, v46, v47, s[66:67]
    v_lshl_add_u32 v28, v26, 10, v27
    global_load_ushort v29, v28, s[4:5]
    v_mul_u32_u24 v20, 9280, v25
    v_lshl_add_u32 v20, v26, 1, v20
    v_add_u32 v20, 91472, v20
    ds_read_u16 v31, v20 offset:5152
    v_and_b32 v46, s62, v46
    v_ashrrev_i32 v47, 31, v46
    v_not_b32 v47, v47
    v_or_b32 v47, s63, v47
    v_xor_b32 v46, v46, v47
    v_and_b32 v46, s62, v46
    v_mul_f32 v46, 0xbfb8aa3b, v46
    v_exp_f32 v46, v46
    s_nop 0
    v_add_f32 v46, 1.0, v46
    v_rcp_f32 v46, v46
    s_nop 0
    v_cvt_pk_bf16_f32 v46, v46, v46
    v_lshlrev_b32 v46, 16, v46
    v_mov_b32 v33, v46
    v_mov_b32 v18, 86352
    s_mov_b32 s41, 0
L_ycnt_lw:
    ds_read_b32 v19, v18
    s_add_u32 s41, s41, 1
    s_cmp_gt_u32 s41, 1000000
    s_cbranch_scc1 L_ycnt_lwd
    s_waitcnt lgkmcnt(0)
    v_cmp_gt_u32 vcc, 4, v19
    s_nop 0
    s_cbranch_vccz L_ycnt_lwd
    s_sleep 4
    s_branch L_ycnt_lw
L_ycnt_lwd:
    s_waitcnt lgkmcnt(0)
    v_lshlrev_b32 v20, 12, v25
    v_lshl_add_u32 v20, v26, 1, v20
    v_add_u32 v20, 135632, v20
    ds_read_u16 v32, v20
    s_waitcnt vmcnt(0) lgkmcnt(0)
    v_lshlrev_b32 v29, 16, v29
    v_lshlrev_b32 v30, 16, v30
    v_lshlrev_b32 v31, 16, v31
    v_lshlrev_b32 v32, 16, v32
    v_mul_f32 v34, v31, v30
    v_cvt_pk_bf16_f32 v34, v34, v34
    v_lshlrev_b32 v34, 16, v34
    v_add_f32 v34, v32, v34
    v_cvt_pk_bf16_f32 v34, v34, v34
    v_lshlrev_b32 v34, 16, v34
    v_add_f32 v34, v29, v34
    v_cvt_pk_bf16_f32 v34, v34, v34
    v_lshlrev_b32 v34, 16, v34
    s_mov_b32 s64, -1
    s_mov_b32 s65, 0xffff
    v_mov_b32 v48, 0
    v_mov_b32 v49, 0
    v_mov_b32 v50, 0
    v_mov_b32 v51, 0
    s_cmp_ge_u32 s2, 224
    s_cbranch_scc1 L_a2_probe
    v_mov_b32 v18, 86380
    s_mov_b32 s41, 0
L_e3i_lw:
    ds_read_b32 v19, v18
    s_add_u32 s41, s41, 1
    s_cmp_gt_u32 s41, 1000000
    s_cbranch_scc1 L_e3i_lwd
    s_waitcnt lgkmcnt(0)
    v_cmp_gt_u32 vcc, 1, v19
    s_nop 0
    s_cbranch_vccz L_e3i_lwd
    s_sleep 2
    s_branch L_e3i_lw
L_e3i_lwd:
    s_waitcnt lgkmcnt(0)
    s_sleep 10
    s_branch L_a2_go
L_a2_probe:
    v_mov_b32 v18, 0x6f000
    s_mov_b32 s41, 0
    s_mov_b64 exec, 1
L_e3_probe:
    global_load_dwordx4 v[44:47], v18, s[58:59] sc1
    s_add_u32 s41, s41, 1
    s_cmp_gt_u32 s41, 100000
    s_cbranch_scc1 L_e3_pdone
    s_waitcnt vmcnt(0)
    v_cmp_ne_u32 vcc, s33, v46
    s_nop 0
    s_cbranch_vccz L_e3_pdone
    s_sleep 12
    s_branch L_e3_probe
L_e3_pdone:
    s_waitcnt vmcnt(0)
    s_mov_b64 exec, -1
L_a2_go:
    global_load_dwordx4 v[44:47], v16, s[58:59] sc1
    s_mov_b64 exec, s[64:65]
    global_load_dwordx4 v[48:51], v17, s[58:59] sc1
    s_mov_b64 exec, -1
    s_mov_b32 s41, 0
L_e3_loop:
    s_waitcnt vmcnt(0)
    s_mov_b64 s[42:43], 0
    v_cmp_ne_u32 vcc, s33, v46
    s_or_b64 s[42:43], s[42:43], vcc
    v_cmp_ne_u32 vcc, s33, v50
    s_and_b64 vcc, vcc, s[64:65]
    s_or_b64 s[42:43], s[42:43], vcc
    s_cmp_eq_u64 s[42:43], 0
    s_cbranch_scc1 L_e3_done
    s_add_u32 s41, s41, 1
    s_cmp_gt_u32 s41, 100000
    s_cbranch_scc1 L_e3_done
    s_sleep 2
    v_cmp_ne_u32 vcc, s33, v46
    s_mov_b64 exec, vcc
    s_cbranch_execz L_e3_skip0
    global_load_dwordx4 v[44:47], v16, s[58:59] sc1
L_e3_skip0:
    s_mov_b64 exec, -1
    v_cmp_ne_u32 vcc, s33, v50
    s_and_b64 exec, vcc, s[64:65]
    s_cbranch_execz L_e3_skip1
    global_load_dwordx4 v[48:51], v17, s[58:59] sc1
L_e3_skip1:
    s_mov_b64 exec, -1
    s_branch L_e3_loop
L_e3_done:
    v_add_f32 v44, v44, v48
    v_add_f32 v45, v45, v49
    s_nop 0
    v_add_f32_dpp v44, v44, v44 row_ror:2 row_mask:0xf bank_mask:0xf
    v_add_f32_dpp v45, v45, v45 row_ror:2 row_mask:0xf bank_mask:0xf
    s_nop 0
    v_add_f32_dpp v44, v44, v44 row_ror:4 row_mask:0xf bank_mask:0xf
    v_add_f32_dpp v45, v45, v45 row_ror:4 row_mask:0xf bank_mask:0xf
    s_nop 0
    v_add_f32_dpp v44, v44, v44 row_ror:8 row_mask:0xf bank_mask:0xf
    v_add_f32_dpp v45, v45, v45 row_ror:8 row_mask:0xf bank_mask:0xf
    v_mov_b32 v46, v44
    v_mov_b32 v47, v45
    s_nop 0
    v_permlane16_swap_b32 v44, v46
    v_permlane16_swap_b32 v45, v47
    v_add_f32 v44, v44, v46
    v_add_f32 v45, v45, v47
    v_mov_b32 v46, v44
    v_mov_b32 v47, v45
    s_nop 0
    v_permlane32_swap_b32 v44, v46
    v_permlane32_swap_b32 v45, v47
    v_add_f32 v44, v44, v46
    v_add_f32 v45, v45, v47
    v_cmp_eq_u32 vcc, 1, v25
    s_nop 1
    v_cndmask_b32 v44, v44, v45, vcc
    v_cvt_pk_bf16_f32 v44, v44, v44
    v_lshlrev_b32 v44, 16, v44
    v_mul_f32 v44, v44, v33
    v_cvt_pk_bf16_f32 v44, v44, v44
    v_lshlrev_b32 v44, 16, v44
    v_add_f32 v44, v31, v44
    v_cvt_pk_bf16_f32 v44, v44, v44
    v_lshlrev_b32 v44, 16, v44
    v_add_f32 v45, v34, v44
    v_cvt_pk_bf16_f32 v45, v45, v45
    s_mov_b64 exec, 15
    global_store_short v28, v45, s[28:29]
    s_mov_b64 exec, -1
    s_branch L_fin
L_aux:
    s_mov_b32 s60, 0x3fb8aa00
    s_mov_b32 s61, 0x36eca570
    s_mov_b32 s62, 0xffff0000
    s_mov_b32 s63, 0x80000000
    v_mov_b32 v44, 0
    v_mov_b32 v45, 0
    v_mov_b32 v46, 0
    v_mov_b32 v47, 0
    v_lshlrev_b32 v16, 4, v1
    v_add_u32 v17, 91472, v16
    s_mov_b32 exec_hi, 1
    ds_write_b128 v17, v[44:47] offset:0
    ds_write_b128 v17, v[44:47] offset:4640
    ds_write_b128 v17, v[44:47] offset:9280
    ds_write_b128 v17, v[44:47] offset:13920
    v_mov_b32 v17, 88656
    v_mov_b32 v18, 86336
    s_mov_b64 exec, 1
    ds_write_b128 v17, v[44:47]
    ds_write_b128 v17, v[44:47] offset:1408
    ds_write_b128 v18, v[44:47] offset:0
    ds_write_b128 v18, v[44:47] offset:16
    ds_write_b128 v18, v[44:47] offset:32
    ds_write_b128 v18, v[44:47] offset:48
    ds_write_b128 v18, v[44:47] offset:64
    ds_write_b128 v18, v[44:47] offset:80
    ds_write_b128 v18, v[44:47] offset:96
    s_mov_b64 exec, -1
    s_waitcnt lgkmcnt(0)
    s_load_dword s33, s[30:31], 0
    s_add_u32 s35, s2, 6
    s_bfe_u32 s35, s35, 0x20001
    s_lshr_b32 s36, s2, 3
    s_lshl_b32 s36, s36, 1
    s_bitcmp1_b32 s2, 0
    s_addc_u32 s36, s36, 0
    v_lshrrev_b32 v16, 2, v1
    v_and_b32 v17, 3, v1
    v_bfe_u32 v18, v16, 2, 1
    v_lshlrev_b32 v18, 1, v18
    v_xor_b32 v17, v17, v18
    s_lshl_b32 s39, s35, 7
    v_add_u32 v16, s39, v16
    v_mul_u32_u24 v16, 3584, v16
    v_lshl_add_u32 v16, v17, 4, v16
    s_lshl_b32 s39, s36, 6
    v_add_u32 v22, s39, v16
    s_lshl_b32 s39, s36, 15
    s_lshl_b32 s40, s35, 8
    s_add_u32 s39, s39, s40
    s_add_u32 s46, s26, s39
    s_addc_u32 s47, s27, 0
    v_lshlrev_b32 v23, 2, v1
    v_lshlrev_b32 v24, 6, v1
    v_add_u32 v24, 32768, v24
    v_add_u32 v25, 4096, v24
    v_add_u32 v26, 8192, v24
    v_add_u32 v27, 4096, v26
    v_bfe_u32 v28, v1, 2, 2
    v_lshlrev_b32 v28, 6, v28
    v_and_b32 v17, 1, v1
    v_lshl_add_u32 v28, v17, 5, v28
    v_bfe_u32 v17, v1, 1, 1
    v_lshl_add_u32 v28, v17, 3, v28
    v_bfe_u32 v17, v1, 4, 1
    v_lshl_add_u32 v28, v17, 8, v28
    v_add_u32 v28, 110032, v28
    s_lshl_b32 s42, s36, 12
    s_add_u32 s42, s42, 0x10000
    s_add_u32 s52, s30, s42
    s_addc_u32 s53, s31, 0
    s_lshl_b32 s42, s35, 10
    s_lshl_b32 s43, s36, 13
    s_add_u32 s42, s42, s43
    s_add_u32 s42, s42, 0xa00000
    s_add_u32 s50, s30, s42
    s_addc_u32 s51, s31, 0
    v_lshlrev_b32 v29, 4, v1
    v_add_u32 v30, 4096, v29
    s_waitcnt lgkmcnt(0)
    s_add_u32 s33, s33, 0x9e3779b9
    s_barrier
    s_setprio 3
    v_min_u32 v16, 7, v1
    v_lshlrev_b32 v16, 2, v16
    v_add_u32 v16, 86304, v16
    ds_read_b32 v48, v16
    s_lshl_b32 s39, s2, 6
    s_add_u32 s40, s39, 32768
    v_lshl_add_u32 v20, v1, 4, s40
    s_add_u32 s40, s39, 4096
    v_lshl_add_u32 v21, v1, 3, s40
    v_mov_b32 v49, s33
    s_waitcnt lgkmcnt(0)
    s_mov_b64 exec, 0xff
    global_store_dwordx2 v21, v[48:49], s[30:31] sc1
    s_mov_b64 exec, -1
    v_mov_b32 v44, 0
    v_mov_b32 v45, 0
    v_mov_b32 v46, s33
    v_mov_b32 v47, 0
    s_mov_b64 exec, 15
    global_store_dwordx4 v20, v[44:47], s[30:31] sc1
    s_mov_b64 exec, -1
    s_setprio 0
    s_barrier
    s_setprio 3
    v_and_b32 v16, 31, v1
    v_lshlrev_b32 v16, 6, v16
    v_add_u32 v16, 47104, v16
    s_mov_b32 s41, 0
    s_mov_b32 exec_lo, 0xffffffff
    s_mov_b32 exec_hi, 0
L_hint_loop:
    global_load_dwordx4 v[44:47], v16, s[30:31] sc1
    s_add_u32 s41, s41, 1
    s_cmp_gt_u32 s41, 100000
    s_cbranch_scc1 L_hint_done
    s_waitcnt vmcnt(0)
    v_cmp_ne_u32 vcc, s33, v46
    s_nop 0
    s_cbranch_vccz L_hint_done
    s_sleep 1
    s_branch L_hint_loop
L_hint_done:
    s_waitcnt vmcnt(0)
    s_mov_b64 exec, -1
    v_mov_b32 v18, 86392
    v_mov_b32 v19, 1
    s_mov_b64 exec, 1
    ds_add_u32 v18, v19
    s_mov_b64 exec, -1
    v_mov_b32 v18, 86420
    s_mov_b32 s41, 0
L_keys_lw:
    ds_read_b32 v19, v18
    s_add_u32 s41, s41, 1
    s_cmp_gt_u32 s41, 1000000
    s_cbranch_scc1 L_keys_lwd
    s_waitcnt lgkmcnt(0)
    v_cmp_gt_u32 vcc, 4, v19
    s_nop 0
    s_cbranch_vccz L_keys_lwd
    s_branch L_keys_lw
L_keys_lwd:
    s_waitcnt lgkmcnt(0)
    v_lshlrev_b32 v16, 5, v1
    v_add_u32 v16, 86608, v16
    ds_read_b128 v[44:47], v16
    ds_read_b128 v[48:51], v16 offset:16
    s_waitcnt lgkmcnt(0)
    v_max_u32 v45, v45, v47
    v_med3_u32 v45, v44, v46, v45
    v_max_u32 v44, v44, v46
    v_max_u32 v45, v45, v49
    v_med3_u32 v45, v44, v48, v45
    v_max_u32 v44, v44, v48
    v_max_u32 v45, v45, v51
    v_med3_u32 v45, v44, v50, v45
    v_max_u32 v44, v44, v50
    v_mov_b32 v46, v44
    s_nop 1
    v_max_u32_dpp v46, v46, v46 row_shr:1 row_mask:0xf bank_mask:0xf bound_ctrl:1
    s_nop 1
    v_max_u32_dpp v46, v46, v46 row_shr:2 row_mask:0xf bank_mask:0xf bound_ctrl:1
    s_nop 1
    v_max_u32_dpp v46, v46, v46 row_shr:4 row_mask:0xf bank_mask:0xf bound_ctrl:1
    s_nop 1
    v_max_u32_dpp v46, v46, v46 row_shr:8 row_mask:0xf bank_mask:0xf bound_ctrl:1
    s_nop 1
    v_max_u32_dpp v46, v46, v46 row_bcast:15 row_mask:0xa bank_mask:0xf
    s_nop 1
    v_max_u32_dpp v46, v46, v46 row_bcast:31 row_mask:0xc bank_mask:0xf
    s_nop 0
    v_readlane_b32 s44, v46, 63
    s_nop 1
    v_cmp_eq_u32 vcc, s44, v44
    s_nop 1
    v_cndmask_b32 v46, v44, v45, vcc
    s_nop 1
    v_max_u32_dpp v46, v46, v46 row_shr:1 row_mask:0xf bank_mask:0xf bound_ctrl:1
    s_nop 1
    v_max_u32_dpp v46, v46, v46 row_shr:2 row_mask:0xf bank_mask:0xf bound_ctrl:1
    s_nop 1
    v_max_u32_dpp v46, v46, v46 row_shr:4 row_mask:0xf bank_mask:0xf bound_ctrl:1
    s_nop 1
    v_max_u32_dpp v46, v46, v46 row_shr:8 row_mask:0xf bank_mask:0xf bound_ctrl:1
    s_nop 1
    v_max_u32_dpp v46, v46, v46 row_bcast:15 row_mask:0xa bank_mask:0xf
    s_nop 1
    v_max_u32_dpp v46, v46, v46 row_bcast:31 row_mask:0xc bank_mask:0xf
    s_nop 0
    v_readlane_b32 s45, v46, 63
    s_and_b32 s48, s44, 0xffff
    s_sub_u32 s48, 0xffff, s48
    s_and_b32 s49, s45, 0xffff
    s_sub_u32 s49, 0xffff, s49
    s_min_u32 s48, s48, 2047
    s_min_u32 s49, s49, 2047
    v_mov_b32 v46, s48
    v_mov_b32 v47, s49
    v_mov_b32 v48, s44
    v_mov_b32 v49, s45
    v_mov_b32 v16, 86336
    s_mov_b64 exec, 1
    ds_write_b64 v16, v[46:47]
    ds_write_b64 v16, v[48:49] offset:8
    s_mov_b64 exec, -1
    s_waitcnt lgkmcnt(0)
    v_mov_b32 v18, 86368
    v_mov_b32 v19, 1
    s_mov_b64 exec, 1
    ds_add_u32 v18, v19
    s_mov_b64 exec, -1
    s_waitcnt lgkmcnt(0)
    s_setprio 0
    s_cmp_ge_u32 s2, 224
    s_cbranch_scc1 L_fin
    s_setprio 3
    v_mov_b32 v18, 86384
    s_mov_b32 s41, 0
L_wrdy_lw:
    ds_read_b32 v19, v18
    s_add_u32 s41, s41, 1
    s_cmp_gt_u32 s41, 1000000
    s_cbranch_scc1 L_wrdy_lwd
    s_waitcnt lgkmcnt(0)
    v_cmp_gt_u32 vcc, 1, v19
    s_nop 0
    s_cbranch_vccz L_wrdy_lwd
    s_sleep 2
    s_branch L_wrdy_lw
L_wrdy_lwd:
    s_waitcnt lgkmcnt(0)
    v_add_u32 v16, 127440, v23
    ds_read_b32 v96, v16 offset:0
    ds_read_b32 v97, v16 offset:256
    ds_read_b32 v98, v16 offset:512
    ds_read_b32 v99, v16 offset:768
    ds_read_b32 v100, v16 offset:1024
    ds_read_b32 v101, v16 offset:1280
    ds_read_b32 v102, v16 offset:1536
    ds_read_b32 v103, v16 offset:1792
    ds_read_b32 v104, v16 offset:2048
    ds_read_b32 v105, v16 offset:2304
    ds_read_b32 v106, v16 offset:2560
    ds_read_b32 v107, v16 offset:2816
    ds_read_b32 v108, v16 offset:3072
    ds_read_b32 v109, v16 offset:3328
    ds_read_b32 v110, v16 offset:3584
    ds_read_b32 v111, v16 offset:3840
    ds_read_b32 v112, v16 offset:4096
    ds_read_b32 v113, v16 offset:4352
    ds_read_b32 v114, v16 offset:4608
    ds_read_b32 v115, v16 offset:4864
    ds_read_b32 v116, v16 offset:5120
    ds_read_b32 v117, v16 offset:5376
    ds_read_b32 v118, v16 offset:5632
    ds_read_b32 v119, v16 offset:5888
    ds_read_b32 v120, v16 offset:6144
    ds_read_b32 v121, v16 offset:6400
    ds_read_b32 v122, v16 offset:6656
    ds_read_b32 v123, v16 offset:6912
    ds_read_b32 v124, v16 offset:7168
    ds_read_b32 v125, v16 offset:7424
    ds_read_b32 v126, v16 offset:7680
    ds_read_b32 v127, v16 offset:7936
    s_mov_b32 s39, 0x05040100
    s_mov_b32 s40, 0x07060302
    s_waitcnt lgkmcnt(15)
    v_perm_b32 v64, v97, v96, s39
    v_perm_b32 v65, v97, v96, s40
    v_perm_b32 v66, v99, v98, s39
    v_perm_b32 v67, v99, v98, s40
    v_perm_b32 v68, v101, v100, s39
    v_perm_b32 v69, v101, v100, s40
    v_perm_b32 v70, v103, v102, s39
    v_perm_b32 v71, v103, v102, s40
    s_waitcnt lgkmcnt(15)
    v_perm_b32 v72, v105, v104, s39
    v_perm_b32 v73, v105, v104, s40
    v_perm_b32 v74, v107, v106, s39
    v_perm_b32 v75, v107, v106, s40
    v_perm_b32 v76, v109, v108, s39
    v_perm_b32 v77, v109, v108, s40
    v_perm_b32 v78, v111, v110, s39
    v_perm_b32 v79, v111, v110, s40
    s_waitcnt lgkmcnt(8)
    v_perm_b32 v80, v113, v112, s39
    v_perm_b32 v81, v113, v112, s40
    v_perm_b32 v82, v115, v114, s39
    v_perm_b32 v83, v115, v114, s40
    v_perm_b32 v84, v117, v116, s39
    v_perm_b32 v85, v117, v116, s40
    v_perm_b32 v86, v119, v118, s39
    v_perm_b32 v87, v119, v118, s40
    s_waitcnt lgkmcnt(0)
    v_perm_b32 v88, v121, v120, s39
    v_perm_b32 v89, v121, v120, s40
    v_perm_b32 v90, v123, v122, s39
    v_perm_b32 v91, v123, v122, s40
    v_perm_b32 v92, v125, v124, s39
    v_perm_b32 v93, v125, v124, s40
    v_perm_b32 v94, v127, v126, s39
    v_perm_b32 v95, v127, v126, s40
    s_add_u32 s42, s35, 1
    s_and_b32 s42, s42, 3
    s_lshl_b32 s42, s42, 10
    v_add_u32 v17, s42, v29
    s_add_u32 s42, s35, 2
    s_and_b32 s42, s42, 3
    s_lshl_b32 s42, s42, 10
    v_add_u32 v18, s42, v29
    s_add_u32 s42, s35, 3
    s_and_b32 s42, s42, 3
    s_lshl_b32 s42, s42, 10
    v_add_u32 v19, s42, v29
    v_mov_b32 v20, 86376
    s_mov_b32 s41, 0
L_eai_lw:
    ds_read_b32 v21, v20
    s_add_u32 s41, s41, 1
    s_cmp_gt_u32 s41, 1000000
    s_cbranch_scc1 L_eai_lwd
    s_waitcnt lgkmcnt(0)
    v_cmp_gt_u32 vcc, 4, v21
    s_nop 0
    s_cbranch_vccz L_eai_lwd
    s_sleep 1
    s_branch L_eai_lw
L_eai_lwd:
    s_waitcnt lgkmcnt(0)
    v_lshlrev_b32 v16, 3, v1
    v_add_u32 v16, 110544, v16
    ds_read_b64 v[56:57], v16
    s_sleep 18
    global_load_dwordx4 v[44:47], v17, s[52:53] sc1
    global_load_dwordx4 v[48:51], v18, s[52:53] sc1
    global_load_dwordx4 v[52:55], v19, s[52:53] sc1
    s_mov_b32 s41, 0
L_ea_loop:
    s_waitcnt vmcnt(0)
    s_mov_b64 s[42:43], 0
    v_cmp_ne_u32 vcc, s33, v46
    s_or_b64 s[42:43], s[42:43], vcc
    v_cmp_ne_u32 vcc, s33, v50
    s_or_b64 s[42:43], s[42:43], vcc
    v_cmp_ne_u32 vcc, s33, v54
    s_or_b64 s[42:43], s[42:43], vcc
    s_cmp_eq_u64 s[42:43], 0
    s_cbranch_scc1 L_ea_done
    s_add_u32 s41, s41, 1
    s_cmp_gt_u32 s41, 100000
    s_cbranch_scc1 L_ea_done
    s_sleep 2
    v_cmp_ne_u32 vcc, s33, v46
    s_mov_b64 exec, vcc
    s_cbranch_execz L_ea_skip0
    global_load_dwordx4 v[44:47], v17, s[52:53] sc1
L_ea_skip0:
    s_mov_b64 exec, -1
    v_cmp_ne_u32 vcc, s33, v50
    s_mov_b64 exec, vcc
    s_cbranch_execz L_ea_skip1
    global_load_dwordx4 v[48:51], v18, s[52:53] sc1
L_ea_skip1:
    s_mov_b64 exec, -1
    v_cmp_ne_u32 vcc, s33, v54
    s_mov_b64 exec, vcc
    s_cbranch_execz L_ea_skip2
    global_load_dwordx4 v[52:55], v19, s[52:53] sc1
L_ea_skip2:
    s_mov_b64 exec, -1
    s_branch L_ea_loop
L_ea_done:
    s_setprio 3
    s_waitcnt lgkmcnt(0)
    v_add_f32 v44, v44, v48
    v_add_f32 v45, v45, v49
    v_add_f32 v52, v52, v56
    v_add_f32 v53, v53, v57
    v_add_f32 v44, v44, v52
    v_add_f32 v45, v45, v53
    v_mov_b32 v46, v44
    v_mov_b32 v47, v45
    s_nop 0
    v_permlane32_swap_b32 v44, v46
    v_permlane32_swap_b32 v45, v47
    v_cmp_gt_u32 vcc, 32, v1
    s_nop 1
    v_cndmask_b32 v44, v45, v44, vcc
    v_cndmask_b32 v46, v47, v46, vcc
    v_cvt_pk_bf16_f32 v44, v44, v44
    v_lshlrev_b32 v44, 16, v44
    v_cvt_pk_bf16_f32 v46, v46, v46
    v_lshlrev_b32 v46, 16, v46
    v_mul_f32 v48, 0xbfb8aa3b, v44
    v_exp_f32 v48, v48
    s_nop 0
    v_add_f32 v48, 1.0, v48
    v_rcp_f32 v48, v48
    s_nop 0
    v_mul_f32 v44, v44, v48
    v_cvt_pk_bf16_f32 v44, v44, v44
    v_lshlrev_b32 v44, 16, v44
    v_mul_f32 v44, v44, v46
    v_cvt_pk_bf16_f32 v44, v44, v44
    v_lshlrev_b32 v16, 1, v1
    v_add_u32 v16, 86448, v16
    ds_write_b16 v16, v44
    v_mov_b32 v16, 86448
    s_waitcnt lgkmcnt(0)
    ds_read_b128 v[96:99], v16 offset:0
    ds_read_b128 v[100:103], v16 offset:16
    ds_read_b128 v[104:107], v16 offset:32
    ds_read_b128 v[108:111], v16 offset:48
    ds_read_b128 v[112:115], v16 offset:64
    ds_read_b128 v[116:119], v16 offset:80
    ds_read_b128 v[120:123], v16 offset:96
    ds_read_b128 v[124:127], v16 offset:112
    v_mov_b32 v44, 0
    v_mov_b32 v45, 0
    v_mov_b32 v48, 0
    v_mov_b32 v49, 0
    v_mov_b32 v46, s33
    v_mov_b32 v47, 0
    v_mov_b32 v50, s33
    v_mov_b32 v51, 0
    s_waitcnt lgkmcnt(4)
    v_dot2_f32_bf16 v44, v64, v96, v44
    v_dot2_f32_bf16 v45, v65, v96, v45
    v_dot2_f32_bf16 v44, v66, v97, v44
    v_dot2_f32_bf16 v45, v67, v97, v45
    v_dot2_f32_bf16 v44, v68, v98, v44
    v_dot2_f32_bf16 v45, v69, v98, v45
    v_dot2_f32_bf16 v44, v70, v99, v44
    v_dot2_f32_bf16 v45, v71, v99, v45
    v_dot2_f32_bf16 v44, v72, v100, v44
    v_dot2_f32_bf16 v45, v73, v100, v45
    v_dot2_f32_bf16 v44, v74, v101, v44
    v_dot2_f32_bf16 v45, v75, v101, v45
    v_dot2_f32_bf16 v44, v76, v102, v44
    v_dot2_f32_bf16 v45, v77, v102, v45
    v_dot2_f32_bf16 v44, v78, v103, v44
    v_dot2_f32_bf16 v45, v79, v103, v45
    v_dot2_f32_bf16 v44, v80, v104, v44
    v_dot2_f32_bf16 v45, v81, v104, v45
    v_dot2_f32_bf16 v44, v82, v105, v44
    v_dot2_f32_bf16 v45, v83, v105, v45
    v_dot2_f32_bf16 v44, v84, v106, v44
    v_dot2_f32_bf16 v45, v85, v106, v45
    v_dot2_f32_bf16 v44, v86, v107, v44
    v_dot2_f32_bf16 v45, v87, v107, v45
    v_dot2_f32_bf16 v44, v88, v108, v44
    v_dot2_f32_bf16 v45, v89, v108, v45
    v_dot2_f32_bf16 v44, v90, v109, v44
    v_dot2_f32_bf16 v45, v91, v109, v45
    v_dot2_f32_bf16 v44, v92, v110, v44
    v_dot2_f32_bf16 v45, v93, v110, v45
    v_dot2_f32_bf16 v44, v94, v111, v44
    v_dot2_f32_bf16 v45, v95, v111, v45
    s_nop 2
    global_store_dwordx4 v29, v[44:47], s[50:51] sc1
    s_waitcnt lgkmcnt(0)
    v_dot2_f32_bf16 v48, v64, v112, v48
    v_dot2_f32_bf16 v49, v65, v112, v49
    v_dot2_f32_bf16 v48, v66, v113, v48
    v_dot2_f32_bf16 v49, v67, v113, v49
    v_dot2_f32_bf16 v48, v68, v114, v48
    v_dot2_f32_bf16 v49, v69, v114, v49
    v_dot2_f32_bf16 v48, v70, v115, v48
    v_dot2_f32_bf16 v49, v71, v115, v49
    v_dot2_f32_bf16 v48, v72, v116, v48
    v_dot2_f32_bf16 v49, v73, v116, v49
    v_dot2_f32_bf16 v48, v74, v117, v48
    v_dot2_f32_bf16 v49, v75, v117, v49
    v_dot2_f32_bf16 v48, v76, v118, v48
    v_dot2_f32_bf16 v49, v77, v118, v49
    v_dot2_f32_bf16 v48, v78, v119, v48
    v_dot2_f32_bf16 v49, v79, v119, v49
    v_dot2_f32_bf16 v48, v80, v120, v48
    v_dot2_f32_bf16 v49, v81, v120, v49
    v_dot2_f32_bf16 v48, v82, v121, v48
    v_dot2_f32_bf16 v49, v83, v121, v49
    v_dot2_f32_bf16 v48, v84, v122, v48
    v_dot2_f32_bf16 v49, v85, v122, v49
    v_dot2_f32_bf16 v48, v86, v123, v48
    v_dot2_f32_bf16 v49, v87, v123, v49
    v_dot2_f32_bf16 v48, v88, v124, v48
    v_dot2_f32_bf16 v49, v89, v124, v49
    v_dot2_f32_bf16 v48, v90, v125, v48
    v_dot2_f32_bf16 v49, v91, v125, v49
    v_dot2_f32_bf16 v48, v92, v126, v48
    v_dot2_f32_bf16 v49, v93, v126, v49
    v_dot2_f32_bf16 v48, v94, v127, v48
    v_dot2_f32_bf16 v49, v95, v127, v49
    s_nop 2
    global_store_dwordx4 v30, v[48:51], s[50:51] sc1
    v_mov_b32 v18, 86380
    v_mov_b32 v19, 1
    s_mov_b64 exec, 1
    ds_add_u32 v18, v19
    s_mov_b64 exec, -1
    s_branch L_fin
L_fin:
L_end:
    s_endpgm
L_codeend:

.section .rodata,"a"
.p2align 6
.amdhsa_kernel parallel_sum__ssm_conv_s4d__moe_arch_mod__prompt_kernel
  .amdhsa_next_free_vgpr 168
  .amdhsa_next_free_sgpr 102
  .amdhsa_accum_offset 168
  .amdhsa_group_segment_fixed_size 0
  .amdhsa_kernarg_size 120
  .amdhsa_user_sgpr_count 2
  .amdhsa_user_sgpr_kernarg_segment_ptr 1
  .amdhsa_system_sgpr_workgroup_id_x 1
  .amdhsa_float_denorm_mode_32 3
.end_amdhsa_kernel
```
